```python
import torch

def _softmax(x, axis=-1):
    return torch.softmax(x, dim=axis)
def _gelu(x):
    return torch.nn.functional.gelu(x, approximate="tanh")
def _silu(x):
    return torch.nn.functional.silu(x)
def _sigmoid(x):
    return torch.sigmoid(x)
def _layernorm(x, axis=-1, eps=1e-5):
    m = x.mean(dim=axis, keepdim=True)
    v = x.var(dim=axis, keepdim=True, unbiased=False)
    return (x - m) / torch.sqrt(v + eps)
def _scatter_add(tgt, idx, src, axis=0):
    return tgt.clone().index_add_(axis, idx, src)
def _segment_sum(src, seg, n):
    out = torch.zeros((n,) + src.shape[1:], dtype=src.dtype)
    return out.index_add_(0, seg, src)
def _pad(x, pw):
    flat = tuple(v for pair in reversed(pw) for v in pair)
    return torch.nn.functional.pad(x, flat)

kernel_name = 'sequential_preLN__spectral_gfnet__glu_gated_geglu__prompt'

def setup_inputs():

    _w = (lambda a: (lambda t: t.to(torch.bfloat16) if t.is_floating_point() else t)(torch.as_tensor(a)))
    def _A_setup():
        B, S, D = 1, 2048, 512
        Df = D // 2 + 1
        return {
            "x": _w((lambda *s: torch.randn(*s, dtype=torch.bfloat16) * 0.05)(B, S, D)),
            "w_r": _w((lambda *s: torch.randn(*s, dtype=torch.bfloat16) * 0.4)(S, Df) * 0.02),
            "w_i": _w((lambda *s: torch.randn(*s, dtype=torch.bfloat16) * 0.4)(S, Df) * 0.02),
        }
    _A_in = _A_setup()

    def _B_setup():
        B, S, Dm, Df = 1, 2048, 512, 1792
        return {
            "x": _w((lambda *s: torch.randn(*s, dtype=torch.bfloat16) * 0.05)(B, S, Dm)),
            "w_gate": _w((lambda *s: torch.randn(*s, dtype=torch.bfloat16) * 0.4)(Dm, Df) * (Dm ** -0.5)),
            "w_up": _w((lambda *s: torch.randn(*s, dtype=torch.bfloat16) * 0.4)(Dm, Df) * (Dm ** -0.5)),
            "w_down": _w((lambda *s: torch.randn(*s, dtype=torch.bfloat16) * 0.4)(Df, Dm) * (Df ** -0.5)),
        }
    _B_in = _B_setup()

    return {
        "A_x": _A_in["x"],
        "A_w_r": _A_in["w_r"],
        "A_w_i": _A_in["w_i"],
        "B_x": _B_in["x"],
        "B_w_gate": _B_in["w_gate"],
        "B_w_up": _B_in["w_up"],
        "B_w_down": _B_in["w_down"],
    }

def reference(A_x, A_w_r, A_w_i, B_x, B_w_gate, B_w_up, B_w_down):
    def _A_ref(x, w_r, w_i):
        B, S, D = x.shape
        X = (lambda x, axes=(-2,-1): torch.fft.rfft2(x.float(), dim=axes))(x, axes=(-2, -1))
        W = w_r + 1j * w_i
        X = X * W
        y = (lambda x, s, axes=(-2,-1): torch.fft.irfft2(x, s=s, dim=axes).to(torch.bfloat16))(X, (S, D), axes=(-2, -1))
        return y

    def _B_ref(x, w_gate, w_up, w_down):
        g = torch.einsum("bsd,df->bsf", x, w_gate)
        u = torch.einsum("bsd,df->bsf", x, w_up)
        h = _gelu(g) * u
        return torch.einsum("bsf,fd->bsd", h, w_down)

    x = A_x
    h = x + _A_ref(_layernorm(x, axis=-1), A_w_r, A_w_i)
    h2 = h + _B_ref(_layernorm(h, axis=-1), B_w_gate, B_w_up, B_w_down)
    return h2
```

```asm
; @launch grid=(256,1,1) block=(256,1,1) lds=163840
.amdgcn_target "amdgcn-amd-amdhsa--gfx950"
.text
.p2align 12
.fill 832, 4, 0xbf810000
.globl sequential_preLN__spectral_gfnet__glu_gated_geglu__prompt_kernel
.p2align 8
.type sequential_preLN__spectral_gfnet__glu_gated_geglu__prompt_kernel,@function
sequential_preLN__spectral_gfnet__glu_gated_geglu__prompt_kernel:
  s_cmp_ge_u32 s2, 256
  s_cbranch_scc0 L_go
  s_endpgm
L_go:
  s_load_dwordx16 s[4:19], s[0:1], 0
  s_load_dwordx4 s[20:23], s[0:1], 64
  s_getpc_b64 s[60:61]
  s_lshr_b32 s42, s2, 3
  s_lshl_b32 s58, s42, 10
  v_lshl_add_u32 v5, v0, 2, s58
  global_load_dword v254, v5, s[60:61]
  s_and_b32 s41, s2, 7
  s_lshl_b32 s43, s41, 5
  s_add_u32 s43, s43, s42
  v_lshrrev_b32 v4, 5, v0
  v_and_b32 v5, 31, v0
  v_lshlrev_b32 v4, 18, v4
  v_lshlrev_b32 v5, 4, v5
  s_lshl_b32 s50, s43, 10
  v_add3_u32 v251, v4, v5, s50
  v_lshrrev_b32 v6, 6, v0
  v_and_b32 v2, 15, v0
  v_bfe_u32 v3, v0, 4, 2
  v_cvt_f32_u32 v31, v3
  v_cvt_f32_u32 v30, v2
  v_and_b32 v4, 1, v2
  v_lshlrev_b32 v4, 15, v4
  v_lshl_or_b32 v253, v4, 16, v4
  s_mov_b32 s59, 0x3e000000
  v_lshrrev_b32 v4, 1, v2
  v_mul_u32_u24 v5, v4, v3
  v_and_b32 v7, 1, v2
  v_lshl_add_u32 v5, v7, 1, v5
  v_cvt_f32_u32 v5, v5
  v_mul_f32 v5, s59, v5
  v_and_b32 v4, 1, v4
  v_lshlrev_b32 v4, 15, v4
  v_lshl_or_b32 v4, v4, 16, v4
  v_cvt_f32_u32 v7, v6
  v_add_f32 v7, v7, v7
  v_mul_f32 v7, s59, v7
  v_add_f32 v7, s59, v7
  v_add_f32 v213, v5, v7
  v_add_f32 v214, v213, v7
  v_add_f32 v215, v214, v7
  v_cos_f32 v212, v5
  v_cos_f32 v213, v213
  v_cos_f32 v214, v214
  v_cos_f32 v215, v215
  v_cvt_pk_f16_f32 v228, v212, v213
  v_cvt_pk_f16_f32 v230, -v212, -v213
  v_cvt_pk_f16_f32 v229, v214, v215
  v_cvt_pk_f16_f32 v231, -v214, -v215
  v_xor_b32 v232, v4, v228
  v_xor_b32 v233, v4, v229
  v_xor_b32 v234, v4, v230
  v_xor_b32 v235, v4, v231
  v_add_f32 v7, s59, v7
  v_add_f32 v213, v5, v7
  v_add_f32 v214, v213, v7
  v_add_f32 v215, v214, v7
  v_cos_f32 v213, v213
  v_cos_f32 v214, v214
  v_cos_f32 v215, v215
  v_cvt_pk_f16_f32 v236, v212, v213
  v_cvt_pk_f16_f32 v238, v212, v213
  v_cvt_pk_f16_f32 v237, v214, v215
  v_cvt_pk_f16_f32 v239, v214, v215
  v_xor_b32 v240, v4, v236
  v_xor_b32 v241, v4, v237
  v_xor_b32 v242, v4, v238
  v_xor_b32 v243, v4, v239
  s_waitcnt lgkmcnt(0)
  global_load_dwordx4 v[244:247], v251, s[4:5]
  global_load_dwordx4 v[248:251], v251, s[4:5] offset:512
  s_mov_b32 s32, s22
  s_mov_b32 s33, s23
  s_mov_b32 s34, 15728640
  s_mov_b32 s35, 0x20000
  s_mov_b32 s58, 4227072
  buffer_load_dwordx2 v[8:9], off, s[32:35], s58 sc1
  v_and_b32 v1, 63, v0
  v_readfirstlane_b32 s40, v6
  v_lshrrev_b32 v207, 2, v2
  v_and_b32 v206, 3, v2
  v_lshlrev_b32 v17, 4, v1
  s_lshl_b32 s47, s40, 12
  v_and_b32 v5, 0x7f, v0
  v_lshrrev_b32 v5, 1, v5
  v_min_u32 v5, 13, v5
  s_mul_i32 s60, s2, 1792
  s_add_u32 s60, s60, 0
  v_lshl_add_u32 v5, v5, 7, s60
  s_cmp_lt_u32 s40, 2
  s_cselect_b32 s24, s12, s14
  s_cselect_b32 s25, s13, s15
  global_load_dword a248, v5, s[24:25]
  v_mov_b32 v208, -1
  v_mov_b32 v209, -1
  v_mov_b32 v210, -1
  v_mov_b32 v211, -1
  v_lshlrev_b32 v5, 4, v2
  v_lshl_add_u32 v5, v6, 8, v5
  s_and_b32 s56, s42, 7
  s_lshl_b32 s56, s56, 7
  v_xor_b32 v5, s56, v5
  v_lshl_add_u32 v252, v3, 19, v5
  s_add_u32 s51, s50, 2097152
  s_add_u32 s53, s50, 0x40000
  s_add_u32 s54, s51, 0x40000
  buffer_store_dwordx4 v[208:211], v252, s[32:35], s51 offen sc1
  buffer_store_dwordx4 v[208:211], v252, s[32:35], s54 offen sc1
  v_lshrrev_b32 v4, 3, v1
  v_and_b32 v5, 6, v4
  v_and_b32 v7, 7, v1
  v_xor_b32 v5, v5, v7
  v_lshlrev_b32 v5, 4, v5
  v_and_b32 v7, 4, v4
  v_add_u32 v4, v4, v7
  v_mul_u32_u24 v4, 3584, v4
  v_add_u32 v18, v4, v5
  v_add_u32 v19, 56320, v18
  v_add_u32 v20, 12288, v18
  v_add_u32 v21, 68608, v18
  s_mov_b32 s28, s16
  s_mov_b32 s29, s17
  s_mov_b32 s30, 1835008
  s_mov_b32 s31, 0x20000
  s_cmp_lt_u32 s40, 2
  s_cselect_b32 s24, s12, s14
  s_cselect_b32 s25, s13, s15
  s_cmp_lt_u32 s42, 28
  s_cselect_b32 s26, 1835008, 1835008
  s_mov_b32 s27, 0x20000
  s_min_u32 s60, s42, 27
  s_lshr_b32 s60, s60, 1
  s_mov_b32 s63, 0
  s_lshl_b32 s60, s60, 1
  s_and_b32 s61, s40, 1
  s_add_u32 s60, s60, s61
  s_lshl_b32 s65, s60, 7
  s_add_u32 s64, s65, 1835008
  s_mov_b32 s60, s63
  s_mul_i32 s60, s60, 458752
  s_add_u32 s62, s65, s60
  s_mov_b32 s63, 114688
  v_lshlrev_b32 v4, 4, v2
  v_lshl_add_u32 v4, v6, 1, v4
  v_lshlrev_b32 v7, 4, v3
  v_cvt_f32_u32 v7, v7
  s_mov_b32 s59, 0x3b000000
  v_add_u32 v212, 1, v4
  v_cvt_f32_u32 v212, v212
  v_mul_f32 v212, s59, v212
  v_mul_f32 v216, v212, v7
  v_add_u32 v213, 2, v4
  v_cvt_f32_u32 v213, v213
  v_mul_f32 v213, s59, v213
  v_mul_f32 v217, v213, v7
  v_add_u32 v214, 9, v4
  v_cvt_f32_u32 v214, v214
  v_mul_f32 v214, s59, v214
  v_mul_f32 v218, v214, v7
  v_add_u32 v215, 10, v4
  v_cvt_f32_u32 v215, v215
  v_mul_f32 v215, s59, v215
  v_mul_f32 v219, v215, v7
  v_add_f32 v187, v216, v212
  v_cos_f32 v176, v212
  v_cos_f32 v184, v216
  v_sin_f32 v185, v216
  v_cos_f32 v186, v187
  v_sin_f32 v187, v187
  v_add_f32 v191, v217, v213
  v_cos_f32 v178, v213
  v_cos_f32 v188, v217
  v_sin_f32 v189, v217
  v_cos_f32 v190, v191
  v_sin_f32 v191, v191
  v_add_f32 v195, v218, v214
  v_cos_f32 v180, v214
  v_cos_f32 v192, v218
  v_sin_f32 v193, v218
  v_cos_f32 v194, v195
  v_sin_f32 v195, v195
  v_add_f32 v199, v219, v215
  v_cos_f32 v182, v215
  v_cos_f32 v196, v219
  v_sin_f32 v197, v219
  v_cos_f32 v198, v199
  v_sin_f32 v199, v199
  s_mov_b32 s58, 0x3d000000
  v_add_f32 v176, v176, v176
  v_add_f32 v178, v178, v178
  v_add_f32 v180, v180, v180
  v_add_f32 v182, v182, v182
  v_pk_mul_f32 v[184:185], v[184:185], s[58:59] op_sel_hi:[1,0]
  v_pk_mul_f32 v[186:187], v[186:187], s[58:59] op_sel_hi:[1,0]
  v_pk_mul_f32 v[188:189], v[188:189], s[58:59] op_sel_hi:[1,0]
  v_pk_mul_f32 v[190:191], v[190:191], s[58:59] op_sel_hi:[1,0]
  v_pk_mul_f32 v[192:193], v[192:193], s[58:59] op_sel_hi:[1,0]
  v_pk_mul_f32 v[194:195], v[194:195], s[58:59] op_sel_hi:[1,0]
  v_pk_mul_f32 v[196:197], v[196:197], s[58:59] op_sel_hi:[1,0]
  v_pk_mul_f32 v[198:199], v[198:199], s[58:59] op_sel_hi:[1,0]
  v_cvt_pk_f16_f32 v32, v184, v186
  v_cvt_pk_f16_f32 v36, v185, v187
  v_cvt_pk_f16_f32 v48, v188, v190
  v_cvt_pk_f16_f32 v52, v189, v191
  v_cvt_pk_f16_f32 v64, v192, v194
  v_cvt_pk_f16_f32 v68, v193, v195
  v_cvt_pk_f16_f32 v80, v196, v198
  v_cvt_pk_f16_f32 v84, v197, v199
  v_pk_fma_f32 v[184:185], v[186:187], v[176:177], v[184:185] op_sel_hi:[1,0,1] neg_lo:[0,0,1] neg_hi:[0,0,1]
  v_pk_fma_f32 v[188:189], v[190:191], v[178:179], v[188:189] op_sel_hi:[1,0,1] neg_lo:[0,0,1] neg_hi:[0,0,1]
  v_pk_fma_f32 v[192:193], v[194:195], v[180:181], v[192:193] op_sel_hi:[1,0,1] neg_lo:[0,0,1] neg_hi:[0,0,1]
  v_pk_fma_f32 v[196:197], v[198:199], v[182:183], v[196:197] op_sel_hi:[1,0,1] neg_lo:[0,0,1] neg_hi:[0,0,1]
  v_pk_fma_f32 v[186:187], v[184:185], v[176:177], v[186:187] op_sel_hi:[1,0,1] neg_lo:[0,0,1] neg_hi:[0,0,1]
  v_pk_fma_f32 v[190:191], v[188:189], v[178:179], v[190:191] op_sel_hi:[1,0,1] neg_lo:[0,0,1] neg_hi:[0,0,1]
  v_pk_fma_f32 v[194:195], v[192:193], v[180:181], v[194:195] op_sel_hi:[1,0,1] neg_lo:[0,0,1] neg_hi:[0,0,1]
  v_pk_fma_f32 v[198:199], v[196:197], v[182:183], v[198:199] op_sel_hi:[1,0,1] neg_lo:[0,0,1] neg_hi:[0,0,1]
  v_cvt_pk_f16_f32 v33, v184, v186
  v_cvt_pk_f16_f32 v37, v185, v187
  v_cvt_pk_f16_f32 v49, v188, v190
  v_cvt_pk_f16_f32 v53, v189, v191
  v_cvt_pk_f16_f32 v65, v192, v194
  v_cvt_pk_f16_f32 v69, v193, v195
  v_cvt_pk_f16_f32 v81, v196, v198
  v_cvt_pk_f16_f32 v85, v197, v199
  v_pk_fma_f32 v[184:185], v[186:187], v[176:177], v[184:185] op_sel_hi:[1,0,1] neg_lo:[0,0,1] neg_hi:[0,0,1]
  v_pk_fma_f32 v[188:189], v[190:191], v[178:179], v[188:189] op_sel_hi:[1,0,1] neg_lo:[0,0,1] neg_hi:[0,0,1]
  v_pk_fma_f32 v[192:193], v[194:195], v[180:181], v[192:193] op_sel_hi:[1,0,1] neg_lo:[0,0,1] neg_hi:[0,0,1]
  v_pk_fma_f32 v[196:197], v[198:199], v[182:183], v[196:197] op_sel_hi:[1,0,1] neg_lo:[0,0,1] neg_hi:[0,0,1]
  v_pk_fma_f32 v[186:187], v[184:185], v[176:177], v[186:187] op_sel_hi:[1,0,1] neg_lo:[0,0,1] neg_hi:[0,0,1]
  v_pk_fma_f32 v[190:191], v[188:189], v[178:179], v[190:191] op_sel_hi:[1,0,1] neg_lo:[0,0,1] neg_hi:[0,0,1]
  v_pk_fma_f32 v[194:195], v[192:193], v[180:181], v[194:195] op_sel_hi:[1,0,1] neg_lo:[0,0,1] neg_hi:[0,0,1]
  v_pk_fma_f32 v[198:199], v[196:197], v[182:183], v[198:199] op_sel_hi:[1,0,1] neg_lo:[0,0,1] neg_hi:[0,0,1]
  v_cvt_pk_f16_f32 v34, v184, v186
  v_cvt_pk_f16_f32 v38, v185, v187
  v_cvt_pk_f16_f32 v50, v188, v190
  v_cvt_pk_f16_f32 v54, v189, v191
  v_cvt_pk_f16_f32 v66, v192, v194
  v_cvt_pk_f16_f32 v70, v193, v195
  v_cvt_pk_f16_f32 v82, v196, v198
  v_cvt_pk_f16_f32 v86, v197, v199
  v_pk_fma_f32 v[184:185], v[186:187], v[176:177], v[184:185] op_sel_hi:[1,0,1] neg_lo:[0,0,1] neg_hi:[0,0,1]
  v_pk_fma_f32 v[188:189], v[190:191], v[178:179], v[188:189] op_sel_hi:[1,0,1] neg_lo:[0,0,1] neg_hi:[0,0,1]
  v_pk_fma_f32 v[192:193], v[194:195], v[180:181], v[192:193] op_sel_hi:[1,0,1] neg_lo:[0,0,1] neg_hi:[0,0,1]
  v_pk_fma_f32 v[196:197], v[198:199], v[182:183], v[196:197] op_sel_hi:[1,0,1] neg_lo:[0,0,1] neg_hi:[0,0,1]
  v_pk_fma_f32 v[186:187], v[184:185], v[176:177], v[186:187] op_sel_hi:[1,0,1] neg_lo:[0,0,1] neg_hi:[0,0,1]
  v_pk_fma_f32 v[190:191], v[188:189], v[178:179], v[190:191] op_sel_hi:[1,0,1] neg_lo:[0,0,1] neg_hi:[0,0,1]
  v_pk_fma_f32 v[194:195], v[192:193], v[180:181], v[194:195] op_sel_hi:[1,0,1] neg_lo:[0,0,1] neg_hi:[0,0,1]
  v_pk_fma_f32 v[198:199], v[196:197], v[182:183], v[198:199] op_sel_hi:[1,0,1] neg_lo:[0,0,1] neg_hi:[0,0,1]
  v_cvt_pk_f16_f32 v35, v184, v186
  v_cvt_pk_f16_f32 v39, v185, v187
  v_cvt_pk_f16_f32 v51, v188, v190
  v_cvt_pk_f16_f32 v55, v189, v191
  v_cvt_pk_f16_f32 v67, v192, v194
  v_cvt_pk_f16_f32 v71, v193, v195
  v_cvt_pk_f16_f32 v83, v196, v198
  v_cvt_pk_f16_f32 v87, v197, v199
  v_pk_fma_f32 v[184:185], v[186:187], v[176:177], v[184:185] op_sel_hi:[1,0,1] neg_lo:[0,0,1] neg_hi:[0,0,1]
  v_pk_fma_f32 v[188:189], v[190:191], v[178:179], v[188:189] op_sel_hi:[1,0,1] neg_lo:[0,0,1] neg_hi:[0,0,1]
  v_pk_fma_f32 v[192:193], v[194:195], v[180:181], v[192:193] op_sel_hi:[1,0,1] neg_lo:[0,0,1] neg_hi:[0,0,1]
  v_pk_fma_f32 v[196:197], v[198:199], v[182:183], v[196:197] op_sel_hi:[1,0,1] neg_lo:[0,0,1] neg_hi:[0,0,1]
  v_pk_fma_f32 v[186:187], v[184:185], v[176:177], v[186:187] op_sel_hi:[1,0,1] neg_lo:[0,0,1] neg_hi:[0,0,1]
  v_pk_fma_f32 v[190:191], v[188:189], v[178:179], v[190:191] op_sel_hi:[1,0,1] neg_lo:[0,0,1] neg_hi:[0,0,1]
  v_pk_fma_f32 v[194:195], v[192:193], v[180:181], v[194:195] op_sel_hi:[1,0,1] neg_lo:[0,0,1] neg_hi:[0,0,1]
  v_pk_fma_f32 v[198:199], v[196:197], v[182:183], v[198:199] op_sel_hi:[1,0,1] neg_lo:[0,0,1] neg_hi:[0,0,1]
  v_cvt_pk_f16_f32 v40, v184, v186
  v_cvt_pk_f16_f32 v44, v185, v187
  v_cvt_pk_f16_f32 v56, v188, v190
  v_cvt_pk_f16_f32 v60, v189, v191
  v_cvt_pk_f16_f32 v72, v192, v194
  v_cvt_pk_f16_f32 v76, v193, v195
  v_cvt_pk_f16_f32 v88, v196, v198
  v_cvt_pk_f16_f32 v92, v197, v199
  v_pk_fma_f32 v[184:185], v[186:187], v[176:177], v[184:185] op_sel_hi:[1,0,1] neg_lo:[0,0,1] neg_hi:[0,0,1]
  v_pk_fma_f32 v[188:189], v[190:191], v[178:179], v[188:189] op_sel_hi:[1,0,1] neg_lo:[0,0,1] neg_hi:[0,0,1]
  v_pk_fma_f32 v[192:193], v[194:195], v[180:181], v[192:193] op_sel_hi:[1,0,1] neg_lo:[0,0,1] neg_hi:[0,0,1]
  v_pk_fma_f32 v[196:197], v[198:199], v[182:183], v[196:197] op_sel_hi:[1,0,1] neg_lo:[0,0,1] neg_hi:[0,0,1]
  v_pk_fma_f32 v[186:187], v[184:185], v[176:177], v[186:187] op_sel_hi:[1,0,1] neg_lo:[0,0,1] neg_hi:[0,0,1]
  v_pk_fma_f32 v[190:191], v[188:189], v[178:179], v[190:191] op_sel_hi:[1,0,1] neg_lo:[0,0,1] neg_hi:[0,0,1]
  v_pk_fma_f32 v[194:195], v[192:193], v[180:181], v[194:195] op_sel_hi:[1,0,1] neg_lo:[0,0,1] neg_hi:[0,0,1]
  v_pk_fma_f32 v[198:199], v[196:197], v[182:183], v[198:199] op_sel_hi:[1,0,1] neg_lo:[0,0,1] neg_hi:[0,0,1]
  v_cvt_pk_f16_f32 v41, v184, v186
  v_cvt_pk_f16_f32 v45, v185, v187
  v_cvt_pk_f16_f32 v57, v188, v190
  v_cvt_pk_f16_f32 v61, v189, v191
  v_cvt_pk_f16_f32 v73, v192, v194
  v_cvt_pk_f16_f32 v77, v193, v195
  v_cvt_pk_f16_f32 v89, v196, v198
  v_cvt_pk_f16_f32 v93, v197, v199
  v_pk_fma_f32 v[184:185], v[186:187], v[176:177], v[184:185] op_sel_hi:[1,0,1] neg_lo:[0,0,1] neg_hi:[0,0,1]
  v_pk_fma_f32 v[188:189], v[190:191], v[178:179], v[188:189] op_sel_hi:[1,0,1] neg_lo:[0,0,1] neg_hi:[0,0,1]
  v_pk_fma_f32 v[192:193], v[194:195], v[180:181], v[192:193] op_sel_hi:[1,0,1] neg_lo:[0,0,1] neg_hi:[0,0,1]
  v_pk_fma_f32 v[196:197], v[198:199], v[182:183], v[196:197] op_sel_hi:[1,0,1] neg_lo:[0,0,1] neg_hi:[0,0,1]
  v_pk_fma_f32 v[186:187], v[184:185], v[176:177], v[186:187] op_sel_hi:[1,0,1] neg_lo:[0,0,1] neg_hi:[0,0,1]
  v_pk_fma_f32 v[190:191], v[188:189], v[178:179], v[190:191] op_sel_hi:[1,0,1] neg_lo:[0,0,1] neg_hi:[0,0,1]
  v_pk_fma_f32 v[194:195], v[192:193], v[180:181], v[194:195] op_sel_hi:[1,0,1] neg_lo:[0,0,1] neg_hi:[0,0,1]
  v_pk_fma_f32 v[198:199], v[196:197], v[182:183], v[198:199] op_sel_hi:[1,0,1] neg_lo:[0,0,1] neg_hi:[0,0,1]
  v_cvt_pk_f16_f32 v42, v184, v186
  v_cvt_pk_f16_f32 v46, v185, v187
  v_cvt_pk_f16_f32 v58, v188, v190
  v_cvt_pk_f16_f32 v62, v189, v191
  v_cvt_pk_f16_f32 v74, v192, v194
  v_cvt_pk_f16_f32 v78, v193, v195
  v_cvt_pk_f16_f32 v90, v196, v198
  v_cvt_pk_f16_f32 v94, v197, v199
  v_pk_fma_f32 v[184:185], v[186:187], v[176:177], v[184:185] op_sel_hi:[1,0,1] neg_lo:[0,0,1] neg_hi:[0,0,1]
  v_pk_fma_f32 v[188:189], v[190:191], v[178:179], v[188:189] op_sel_hi:[1,0,1] neg_lo:[0,0,1] neg_hi:[0,0,1]
  v_pk_fma_f32 v[192:193], v[194:195], v[180:181], v[192:193] op_sel_hi:[1,0,1] neg_lo:[0,0,1] neg_hi:[0,0,1]
  v_pk_fma_f32 v[196:197], v[198:199], v[182:183], v[196:197] op_sel_hi:[1,0,1] neg_lo:[0,0,1] neg_hi:[0,0,1]
  v_pk_fma_f32 v[186:187], v[184:185], v[176:177], v[186:187] op_sel_hi:[1,0,1] neg_lo:[0,0,1] neg_hi:[0,0,1]
  v_pk_fma_f32 v[190:191], v[188:189], v[178:179], v[190:191] op_sel_hi:[1,0,1] neg_lo:[0,0,1] neg_hi:[0,0,1]
  v_pk_fma_f32 v[194:195], v[192:193], v[180:181], v[194:195] op_sel_hi:[1,0,1] neg_lo:[0,0,1] neg_hi:[0,0,1]
  v_pk_fma_f32 v[198:199], v[196:197], v[182:183], v[198:199] op_sel_hi:[1,0,1] neg_lo:[0,0,1] neg_hi:[0,0,1]
  v_cvt_pk_f16_f32 v43, v184, v186
  v_cvt_pk_f16_f32 v47, v185, v187
  v_cvt_pk_f16_f32 v59, v188, v190
  v_cvt_pk_f16_f32 v63, v189, v191
  v_cvt_pk_f16_f32 v75, v192, v194
  v_cvt_pk_f16_f32 v79, v193, v195
  v_cvt_pk_f16_f32 v91, v196, v198
  v_cvt_pk_f16_f32 v95, v197, v199
  v_lshrrev_b32 v4, 5, v0
  v_and_b32 v5, 31, v0
  v_lshlrev_b32 v5, 4, v5
  v_lshl_add_u32 v5, v4, 10, v5
  v_add_u32 v204, 131072, v5
  v_and_b32 v4, 1, v4
  v_lshlrev_b32 v4, 3, v4
  v_and_or_b32 v4, v0, 16, v4
  v_xor_b32 v198, v4, v204
  v_xor_b32 v199, 8, v198
  v_lshlrev_b32 v4, 10, v3
  v_lshl_add_u32 v4, v207, 7, v4
  v_lshl_add_u32 v4, v206, 5, v4
  v_and_b32 v5, 1, v3
  v_and_or_b32 v5, v207, 2, v5
  v_lshl_add_u32 v4, v5, 3, v4
  v_add_u32 v194, 131072, v4
  v_xor_b32 v195, 8, v194
  v_xor_b32 v196, 16, v194
  v_xor_b32 v197, 24, v194
  v_bfe_u32 v5, v0, 4, 3
  v_mul_u32_u24 v5, 4112, v5
  v_mad_u32_u24 v7, v2, 34, v5
  s_mul_i32 s52, s41, 514
  s_mul_i32 s59, s42, 32896
  s_add_u32 s59, s59, s52
  v_add_u32 v7, s59, v7
  s_cmp_lt_u32 s40, 2
  s_cselect_b32 s60, s6, s8
  s_cselect_b32 s61, s7, s9
  global_load_dword v255, v7, s[60:61]
  s_mov_b64 exec, 0
  s_cmp_eq_u32 s40, 0
  s_cbranch_scc1 L_page1
  s_cmp_eq_u32 s40, 1
  s_cbranch_scc1 L_page2
  s_cmp_eq_u32 s40, 2
  s_cbranch_scc1 L_page3
L_hop123:
  s_mov_b64 exec, -1
  s_mov_b32 s57, 0xffff0000
  s_mov_b32 s55, 0x70007
  s_waitcnt vmcnt(5)
  v_lshlrev_b32 v176, 16, v244
  v_and_b32 v177, s57, v244
  v_lshlrev_b32 v178, 16, v245
  v_and_b32 v179, s57, v245
  v_lshlrev_b32 v180, 16, v246
  v_and_b32 v181, s57, v246
  v_lshlrev_b32 v182, 16, v247
  v_and_b32 v183, s57, v247
  v_lshlrev_b32 v184, 16, v248
  v_and_b32 v185, s57, v248
  v_lshlrev_b32 v186, 16, v249
  v_and_b32 v187, s57, v249
  v_lshlrev_b32 v188, 16, v250
  v_and_b32 v189, s57, v250
  v_lshlrev_b32 v190, 16, v251
  v_and_b32 v191, s57, v251
  v_pk_add_f32 v[212:213], v[176:177], v[178:179]
  v_pk_add_f32 v[214:215], v[180:181], v[182:183]
  v_pk_mul_f32 v[216:217], v[176:177], v[176:177]
  v_pk_mul_f32 v[218:219], v[178:179], v[178:179]
  v_pk_fma_f32 v[216:217], v[180:181], v[180:181], v[216:217]
  v_pk_fma_f32 v[218:219], v[182:183], v[182:183], v[218:219]
  v_pk_add_f32 v[212:213], v[212:213], v[184:185]
  v_pk_fma_f32 v[216:217], v[184:185], v[184:185], v[216:217]
  v_pk_add_f32 v[214:215], v[214:215], v[186:187]
  v_pk_fma_f32 v[218:219], v[186:187], v[186:187], v[218:219]
  v_pk_add_f32 v[212:213], v[212:213], v[188:189]
  v_pk_fma_f32 v[216:217], v[188:189], v[188:189], v[216:217]
  v_pk_add_f32 v[214:215], v[214:215], v[190:191]
  v_pk_fma_f32 v[218:219], v[190:191], v[190:191], v[218:219]
  v_pk_add_f32 v[212:213], v[212:213], v[214:215]
  v_pk_add_f32 v[216:217], v[216:217], v[218:219]
  v_add_f32 v212, v212, v213
  v_add_f32 v216, v216, v217
  s_mov_b32 s58, 0x3b000000
  s_mov_b32 s59, 0x42800000
  v_permlane16_swap_b32 v212, v216
  v_add_f32 v212, v212, v216
  s_waitcnt vmcnt(4)
  v_add_u32 v8, 0x7f4a7c15, v8
  v_add_u32 v9, 0x9e3779b9, v9
  v_add_f32_dpp v212, v212, v212 quad_perm:[1,0,3,2] row_mask:0xf bank_mask:0xf
  v_ashrrev_i32 v201, 31, v253
  v_bfi_b32 v200, v201, v9, v8
  v_add_f32_dpp v212, v212, v212 quad_perm:[2,3,0,1] row_mask:0xf bank_mask:0xf
  v_and_b32 v200, -9, v200
  v_or_b32 v200, 1, v200
  v_add_f32_dpp v212, v212, v212 row_half_mirror row_mask:0xf bank_mask:0xf
  v_lshrrev_b32 v201, 3, v200
  v_lshrrev_b32 v202, 6, v200
  v_add_f32_dpp v212, v212, v212 row_mirror row_mask:0xf bank_mask:0xf
  v_mul_f32 v216, s58, v212
  v_mul_f32 v212, s58, v212
  v_lshrrev_b32 v203, 9, v200
  v_mov_b32 v215, 0x3a27c5ac
  v_permlane16_swap_b32 v212, v216
  v_fma_f32 v216, -v212, v212, v216
  v_max_f32 v216, 0, v216
  v_fma_f32 v216, v216, s59, v215
  v_rsq_f32 v216, v216
  v_readlane_b32 s20, v212, 0
  v_mul_f32 v214, v212, v216
  v_pk_fma_f32 v[176:177], v[176:177], v[216:217], v[214:215] op_sel_hi:[1,0,0] neg_lo:[0,0,1] neg_hi:[0,0,1]
  v_pk_fma_f32 v[178:179], v[178:179], v[216:217], v[214:215] op_sel_hi:[1,0,0] neg_lo:[0,0,1] neg_hi:[0,0,1]
  v_pk_fma_f32 v[184:185], v[184:185], v[216:217], v[214:215] op_sel_hi:[1,0,0] neg_lo:[0,0,1] neg_hi:[0,0,1]
  v_pk_fma_f32 v[186:187], v[186:187], v[216:217], v[214:215] op_sel_hi:[1,0,0] neg_lo:[0,0,1] neg_hi:[0,0,1]
  v_cvt_pk_f16_f32 v168, v176, v177
  v_cvt_pk_f16_f32 v169, v178, v179
  v_cvt_pk_f16_f32 v172, v184, v185
  v_cvt_pk_f16_f32 v173, v186, v187
  ds_write2_b64 v198, v[168:169], v[172:173] offset0:0 offset1:64
  v_pk_fma_f32 v[180:181], v[180:181], v[216:217], v[214:215] op_sel_hi:[1,0,0] neg_lo:[0,0,1] neg_hi:[0,0,1]
  v_pk_fma_f32 v[182:183], v[182:183], v[216:217], v[214:215] op_sel_hi:[1,0,0] neg_lo:[0,0,1] neg_hi:[0,0,1]
  v_pk_fma_f32 v[188:189], v[188:189], v[216:217], v[214:215] op_sel_hi:[1,0,0] neg_lo:[0,0,1] neg_hi:[0,0,1]
  v_pk_fma_f32 v[190:191], v[190:191], v[216:217], v[214:215] op_sel_hi:[1,0,0] neg_lo:[0,0,1] neg_hi:[0,0,1]
  v_cvt_pk_f16_f32 v170, v180, v181
  v_cvt_pk_f16_f32 v171, v182, v183
  v_cvt_pk_f16_f32 v174, v188, v189
  v_cvt_pk_f16_f32 v175, v190, v191
  ds_write2_b64 v199, v[170:171], v[174:175] offset0:0 offset1:64
  v_readlane_b32 s21, v212, 32
  s_mov_b32 s45, 0
  s_getreg_b32 s46, hwreg(HW_REG_XCC_ID)
  s_and_b32 s46, s46, 15
  v_mov_b32 v10, s46
  s_lshl_b32 s60, s43, 4
  s_add_u32 s60, s60, 4194304
  v_min_u32 v4, 1, v0
  v_lshlrev_b32 v4, 25, v4
  buffer_store_dwordx4 v[8:11], v4, s[32:35], s60 offen sc1
  v_readfirstlane_b32 s48, v8
  v_readfirstlane_b32 s49, v9
  s_mov_b32 s61, 0x40004
  s_waitcnt lgkmcnt(0)
  s_barrier
  ds_read_b64_tr_b16 v[96:97], v194 offset:0
  ds_read_b64_tr_b16 v[98:99], v194 offset:512
  ds_read_b64_tr_b16 v[100:101], v194 offset:4096
  ds_read_b64_tr_b16 v[102:103], v194 offset:4608
  ds_read_b64_tr_b16 v[104:105], v195 offset:0
  ds_read_b64_tr_b16 v[106:107], v195 offset:512
  ds_read_b64_tr_b16 v[108:109], v195 offset:4096
  ds_read_b64_tr_b16 v[110:111], v195 offset:4608
  ds_read_b64_tr_b16 v[112:113], v196 offset:0
  ds_read_b64_tr_b16 v[114:115], v196 offset:512
  ds_read_b64_tr_b16 v[116:117], v196 offset:4096
  ds_read_b64_tr_b16 v[118:119], v196 offset:4608
  ds_read_b64_tr_b16 v[120:121], v197 offset:0
  ds_read_b64_tr_b16 v[122:123], v197 offset:512
  ds_read_b64_tr_b16 v[124:125], v197 offset:4096
  ds_read_b64_tr_b16 v[126:127], v197 offset:4608
  s_waitcnt lgkmcnt(14)
  v_mfma_f32_16x16x32_f16 v[128:131], v[96:99], v[228:231], 0
  s_add_u32 m0, s47, 0
  s_nop 0
  buffer_load_dwordx4 v18, s[24:27], s62 offen offset:0 lds
  v_mfma_f32_16x16x32_f16 v[144:147], v[96:99], v[236:239], 0
  s_waitcnt lgkmcnt(12)
  v_mfma_f32_16x16x32_f16 v[128:131], v[100:103], v[232:235], v[128:131]
  v_mfma_f32_16x16x32_f16 v[144:147], v[100:103], v[240:243], v[144:147]
  s_waitcnt lgkmcnt(10)
  v_mfma_f32_16x16x32_f16 v[132:135], v[104:107], v[228:231], 0
  v_mfma_f32_16x16x32_f16 v[148:151], v[104:107], v[236:239], 0
  s_waitcnt lgkmcnt(8)
  v_mfma_f32_16x16x32_f16 v[132:135], v[108:111], v[232:235], v[132:135]
  s_nop 1
  v_cvt_pk_f16_f32 v176, v128, v129
  buffer_load_dwordx4 v19, s[24:27], s62 offen offset:1024 lds
  v_cvt_pk_f16_f32 v184, v144, v145
  v_mfma_f32_16x16x32_f16 v[148:151], v[108:111], v[240:243], v[148:151]
  s_waitcnt lgkmcnt(6)
  v_cvt_pk_f16_f32 v177, v130, v131
  v_cvt_pk_f16_f32 v185, v146, v147
  v_mfma_f32_16x16x32_f16 v[136:139], v[112:115], v[228:231], 0
  v_xor_b32_dpp v96, v176, v253 quad_perm:[1,0,3,2] row_mask:0xf bank_mask:0xf
  v_xor_b32_dpp v104, v184, v253 quad_perm:[1,0,3,2] row_mask:0xf bank_mask:0xf
  v_mfma_f32_16x16x32_f16 v[152:155], v[112:115], v[236:239], 0
  s_waitcnt lgkmcnt(4)
  v_xor_b32_dpp v97, v177, v253 quad_perm:[1,0,3,2] row_mask:0xf bank_mask:0xf
  v_xor_b32_dpp v105, v185, v253 quad_perm:[1,0,3,2] row_mask:0xf bank_mask:0xf
  v_mfma_f32_16x16x32_f16 v[136:139], v[116:119], v[232:235], v[136:139]
  v_cvt_pk_f16_f32 v178, v132, v133
  v_cvt_pk_f16_f32 v186, v148, v149
  v_mfma_f32_16x16x32_f16 v[152:155], v[116:119], v[240:243], v[152:155]
  s_waitcnt lgkmcnt(2)
  v_cvt_pk_f16_f32 v179, v134, v135
  v_cvt_pk_f16_f32 v187, v150, v151
  v_mfma_f32_16x16x32_f16 v[140:143], v[120:123], v[228:231], 0
  buffer_load_dwordx4 v20, s[24:27], s62 offen offset:2048 lds
  v_xor_b32_dpp v98, v178, v253 quad_perm:[1,0,3,2] row_mask:0xf bank_mask:0xf
  v_xor_b32_dpp v106, v186, v253 quad_perm:[1,0,3,2] row_mask:0xf bank_mask:0xf
  v_mfma_f32_16x16x32_f16 v[156:159], v[120:123], v[236:239], 0
  s_waitcnt lgkmcnt(0)
  v_xor_b32_dpp v99, v179, v253 quad_perm:[1,0,3,2] row_mask:0xf bank_mask:0xf
  v_xor_b32_dpp v107, v187, v253 quad_perm:[1,0,3,2] row_mask:0xf bank_mask:0xf
  v_mfma_f32_16x16x32_f16 v[140:143], v[124:127], v[232:235], v[140:143]
  v_cvt_pk_f16_f32 v180, v136, v137
  v_cvt_pk_f16_f32 v188, v152, v153
  buffer_load_dwordx4 v21, s[24:27], s62 offen offset:3072 lds
  v_mfma_f32_16x16x32_f16 v[156:159], v[124:127], v[240:243], v[156:159]
  v_cvt_pk_f16_f32 v181, v138, v139
  v_cvt_pk_f16_f32 v189, v154, v155
  v_mfma_f32_16x16x32_f16 v[212:215], v[176:179], v[32:35], 0
  v_xor_b32_dpp v100, v180, v253 quad_perm:[1,0,3,2] row_mask:0xf bank_mask:0xf
  v_xor_b32_dpp v108, v188, v253 quad_perm:[1,0,3,2] row_mask:0xf bank_mask:0xf
  v_mfma_f32_16x16x32_f16 v[216:219], v[184:187], v[48:51], 0
  v_xor_b32_dpp v101, v181, v253 quad_perm:[1,0,3,2] row_mask:0xf bank_mask:0xf
  v_xor_b32_dpp v109, v189, v253 quad_perm:[1,0,3,2] row_mask:0xf bank_mask:0xf
  v_mfma_f32_16x16x32_f16 v[220:223], v[176:179], v[64:67], 0
  v_cvt_pk_f16_f32 v182, v140, v141
  v_cvt_pk_f16_f32 v190, v156, v157
  v_mfma_f32_16x16x32_f16 v[224:227], v[184:187], v[80:83], 0
  v_cvt_pk_f16_f32 v183, v142, v143
  v_cvt_pk_f16_f32 v191, v158, v159
  v_mfma_f32_16x16x32_f16 v[212:215], v[96:99], v[36:39], v[212:215]
  v_xor_b32_dpp v102, v182, v253 quad_perm:[1,0,3,2] row_mask:0xf bank_mask:0xf
  v_xor_b32_dpp v110, v190, v253 quad_perm:[1,0,3,2] row_mask:0xf bank_mask:0xf
  v_mfma_f32_16x16x32_f16 v[216:219], v[104:107], v[52:55], v[216:219]
  s_add_u32 m0, s47, 16384
  s_add_u32 s62, s62, s63
  buffer_load_dwordx4 v18, s[24:27], s62 offen offset:0 lds
  v_xor_b32_dpp v103, v183, v253 quad_perm:[1,0,3,2] row_mask:0xf bank_mask:0xf
  v_xor_b32_dpp v111, v191, v253 quad_perm:[1,0,3,2] row_mask:0xf bank_mask:0xf
  v_mfma_f32_16x16x32_f16 v[220:223], v[96:99], v[68:71], v[220:223]
  v_mfma_f32_16x16x32_f16 v[224:227], v[104:107], v[84:87], v[224:227]
  v_mfma_f32_16x16x32_f16 v[212:215], v[180:183], v[40:43], v[212:215]
  v_mfma_f32_16x16x32_f16 v[216:219], v[188:191], v[56:59], v[216:219]
  v_mfma_f32_16x16x32_f16 v[212:215], v[100:103], v[44:47], v[212:215]
  v_mfma_f32_16x16x32_f16 v[216:219], v[108:111], v[60:63], v[216:219]
  v_mfma_f32_16x16x32_f16 v[220:223], v[180:183], v[72:75], v[220:223]
  buffer_load_dwordx4 v19, s[24:27], s62 offen offset:1024 lds
  v_mfma_f32_16x16x32_f16 v[224:227], v[188:191], v[88:91], v[224:227]
  v_mfma_f32_16x16x32_f16 v[220:223], v[100:103], v[76:79], v[220:223]
  s_nop 2
  v_cvt_pk_f16_f32 v128, v212, v213
  v_cvt_pk_f16_f32 v132, v214, v215
  v_mfma_f32_16x16x32_f16 v[224:227], v[108:111], v[92:95], v[224:227]
  s_waitcnt vmcnt(8)
  v_add_u32 v128, s61, v128
  v_add_u32 v132, s61, v132
  v_bfi_b32 v128, s55, v200, v128
  v_bfi_b32 v132, s55, v200, v132
  v_cvt_pk_f16_f32 v129, v216, v217
  v_cvt_pk_f16_f32 v133, v218, v219
  v_add_u32 v129, s61, v129
  v_add_u32 v133, s61, v133
  v_bfi_b32 v129, s55, v201, v129
  v_bfi_b32 v133, s55, v201, v133
  v_cvt_pk_f16_f32 v130, v220, v221
  v_cvt_pk_f16_f32 v134, v222, v223
  v_add_u32 v130, s61, v130
  v_add_u32 v134, s61, v134
  v_bfi_b32 v130, s55, v202, v130
  v_bfi_b32 v134, s55, v202, v134
  v_cvt_pk_f16_f32 v131, v224, v225
  v_cvt_pk_f16_f32 v135, v226, v227
  v_add_u32 v131, s61, v131
  v_add_u32 v135, s61, v135
  v_bfi_b32 v131, s55, v203, v131
  v_bfi_b32 v135, s55, v203, v135
  buffer_store_dwordx4 v[128:131], v252, s[32:35], s50 offen sc1
  buffer_store_dwordx4 v[132:135], v252, s[32:35], s53 offen sc1
  s_mov_b32 s4, s6
  s_mov_b32 s5, s7
  s_mov_b32 s6, 1052672
  s_mov_b32 s7, 0x20000
  s_mov_b32 s10, 1052672
  s_mov_b32 s11, 0x20000
  v_lshrrev_b32 v4, 2, v1
  v_mul_u32_u24 v4, 4112, v4
  v_lshl_add_u32 v205, v206, 4, v4
  s_lshr_b32 s59, s42, 3
  s_lshl_b32 s59, s59, 2
  s_add_u32 s58, s52, s59
  s_and_b32 s59, s42, 7
  s_lshl_b32 s59, s59, 6
  s_add_u32 s58, s58, s59
  s_mul_i32 s59, s40, 263168
  s_add_u32 s58, s58, s59
  s_add_u32 s52, s58, 2
  s_lshr_b32 s3, s47, 2
  s_add_u32 m0, s3, 155648
  s_nop 0
  buffer_load_dword v205, s[4:7], s52 offen lds
  v_lshrrev_b32 v4, 7, v0
  v_bfe_u32 v5, v0, 1, 2
  v_lshlrev_b32 v5, 4, v5
  v_lshl_add_u32 v4, v4, 6, v5
  v_bfe_u32 v5, v0, 3, 4
  v_add_u32 v4, v4, v5
  v_and_b32 v7, 7, v5
  v_and_b32 v5, 1, v0
  v_lshlrev_b32 v5, 4, v5
  v_lshl_add_u32 v5, v7, 7, v5
  s_lshl_b32 s59, s42, 5
  v_xor_b32 v5, s59, v5
  v_lshl_add_u32 v252, v4, 10, v5
  s_lshl_b32 s50, s41, 18
  s_add_u32 s53, s50, 0x20000
  v_and_b32 v200, s55, v200
  v_and_b32 v201, s55, v201
  v_and_b32 v202, s55, v202
  v_and_b32 v203, s55, v203
  ds_write_b128 v204, v[244:247] offset:8192
  ds_write_b128 v204, v[248:251] offset:8704
  v_and_b32 v4, 1, v2
  v_lshl_add_u32 v4, v6, 1, v4
  s_add_u32 m0, s3, 159744
  s_nop 0
  buffer_load_dword v205, s[8:11], s52 offen lds
  v_lshlrev_b32 v4, 10, v4
  v_lshrrev_b32 v5, 1, v2
  v_lshl_add_u32 v4, v5, 7, v4
  v_lshl_add_u32 v4, v3, 4, v4
  v_add_u32 v4, 139264, v4
  ds_read_b128 v[244:247], v4
  ds_read_b128 v[248:251], v4 offset:64
  v_cvt_f32_u32 v204, s41
  s_mov_b32 s58, 0x41000000
  s_mov_b32 s59, 0xbd800000
  v_mul_f32 v212, 4.0, v31
  v_add_f32 v213, 1.0, v212
  v_add_f32 v214, 2.0, v212
  v_add_f32 v215, 2.0, v213
  v_fma_f32 v4, v30, s58, v204
  v_mul_f32 v5, 0x3c000000, v4
  v_mul_f32 v216, v212, v5
  v_mul_f32 v217, v213, v5
L_page1:
  s_cbranch_execz L_hop123
  v_mul_f32 v218, v214, v5
  v_mul_f32 v219, v215, v5
  v_cos_f32 v220, v216
  v_sin_f32 v224, v216
  s_add_u32 m0, s3, 155904
  s_add_u32 s52, s52, 65792
  buffer_load_dword v205, s[4:7], s52 offen lds
  v_cos_f32 v221, v217
  v_sin_f32 v225, v217
  v_cos_f32 v222, v218
  v_sin_f32 v226, v218
  v_cos_f32 v223, v219
  v_sin_f32 v227, v219
  v_cvt_pk_f16_f32 v136, v220, v224
  v_cvt_pk_f16_f32 v140, -v224, v220
  v_cvt_pk_f16_f32 v137, v221, v225
  v_cvt_pk_f16_f32 v141, -v225, v221
  v_cvt_pk_f16_f32 v138, v222, v226
  v_cvt_pk_f16_f32 v142, -v226, v222
  v_cvt_pk_f16_f32 v139, v223, v227
  v_cvt_pk_f16_f32 v143, -v227, v223
  v_mul_f32 v216, s59, v216
  v_mul_f32 v217, s59, v217
  v_mul_f32 v218, s59, v218
  s_add_u32 m0, s3, 160000
  s_nop 0
  buffer_load_dword v205, s[8:11], s52 offen lds
  v_mul_f32 v219, s59, v219
  v_cos_f32 v72, v216
  v_sin_f32 v76, v216
  v_cos_f32 v73, v217
  v_sin_f32 v77, v217
  v_cos_f32 v74, v218
  v_sin_f32 v78, v218
  v_cos_f32 v75, v219
  v_sin_f32 v79, v219
  v_mul_f32 v5, 0x3d800000, v30
  v_mul_f32 v216, v212, v5
  v_mul_f32 v217, v213, v5
  v_mul_f32 v218, v214, v5
  v_mul_f32 v219, v215, v5
  v_cos_f32 v220, v216
  s_add_u32 m0, s3, 156160
  s_add_u32 s52, s52, 65792
  buffer_load_dword v205, s[4:7], s52 offen lds
  v_sin_f32 v224, v216
  v_cos_f32 v221, v217
  v_sin_f32 v225, v217
  v_cos_f32 v222, v218
  v_sin_f32 v226, v218
  v_cos_f32 v223, v219
  v_sin_f32 v227, v219
  v_cvt_pk_f16_f32 v144, v220, v224
  v_cvt_pk_f16_f32 v148, -v224, v220
  v_cvt_pk_f16_f32 v145, v221, v225
  v_cvt_pk_f16_f32 v149, -v225, v221
  v_cvt_pk_f16_f32 v146, v222, v226
  v_cvt_pk_f16_f32 v150, -v226, v222
  v_cvt_pk_f16_f32 v147, v223, v227
  v_cvt_pk_f16_f32 v151, -v227, v223
  v_cvt_pk_bf16_f32 v152, v220, -v224
  s_add_u32 m0, s3, 160256
  s_nop 0
  buffer_load_dword v205, s[8:11], s52 offen lds
  v_cvt_pk_bf16_f32 v156, v224, v220
  v_cvt_pk_bf16_f32 v153, v221, -v225
  v_cvt_pk_bf16_f32 v157, v225, v221
  v_cvt_pk_bf16_f32 v154, v222, -v226
  v_cvt_pk_bf16_f32 v158, v226, v222
  v_cvt_pk_bf16_f32 v155, v223, -v227
  v_cvt_pk_bf16_f32 v159, v227, v223
  v_mul_f32 v5, 0x3c000000, v30
  s_mov_b32 s58, 0x41000000
  s_mov_b32 s59, 0x3d800000
  v_fma_f32 v216, v212, s58, v204
  v_mul_f32 v216, v216, v5
  v_fma_f32 v217, v213, s58, v204
  v_mul_f32 v217, v217, v5
  v_fma_f32 v218, v214, s58, v204
  v_mul_f32 v218, v218, v5
  v_fma_f32 v219, v215, s58, v204
  v_mul_f32 v219, v219, v5
  v_cos_f32 v220, v216
  v_sin_f32 v224, v216
  v_cos_f32 v221, v217
  v_sin_f32 v225, v217
  v_cos_f32 v222, v218
  v_sin_f32 v226, v218
  v_cos_f32 v223, v219
  v_sin_f32 v227, v219
  v_cvt_pk_bf16_f32 v160, v220, -v224
  v_cvt_pk_bf16_f32 v164, v224, v220
  v_cvt_pk_bf16_f32 v161, v221, -v225
  v_cvt_pk_bf16_f32 v165, v225, v221
  v_cvt_pk_bf16_f32 v162, v222, -v226
  v_cvt_pk_bf16_f32 v166, v226, v222
  v_cvt_pk_bf16_f32 v163, v223, -v227
  v_cvt_pk_bf16_f32 v167, v227, v223
  v_mul_f32 v216, s59, v216
  v_mul_f32 v217, s59, v217
  v_mul_f32 v218, s59, v218
  v_mul_f32 v219, s59, v219
  v_cos_f32 v64, v216
  v_sin_f32 v68, v216
  v_cos_f32 v65, v217
  v_sin_f32 v69, v217
  v_cos_f32 v66, v218
  v_sin_f32 v70, v218
  v_cos_f32 v67, v219
  v_sin_f32 v71, v219
  buffer_load_dwordx4 v[56:59], v252, s[32:35], s50 offen sc1
  buffer_load_dwordx4 v[60:63], v252, s[32:35], s53 offen sc1
  v_and_b32 v5, 0x7f, v0
  v_lshrrev_b32 v5, 1, v5
  v_min_u32 v5, 41, v5
  s_mul_i32 s60, s2, 5376
  s_add_u32 s60, s60, 458752
  v_lshl_add_u32 v5, v5, 7, s60
  global_load_dword a250, v5, s[24:25]
  s_add_u32 m0, s3, 156416
  s_add_u32 s52, s52, 65792
  buffer_load_dword v205, s[4:7], s52 offen lds
  s_lshl_b32 s58, s41, 12
  s_lshr_b32 s59, s47, 2
  s_add_u32 s58, s58, s59
  s_add_u32 s58, s58, 4259840
  buffer_load_dword v15, v17, s[32:35], s58 offen sc1
  v_and_b32 v4, 1, v0
  v_mul_u32_u24 v4, 4160, v4
  v_lshrrev_b32 v5, 1, v0
  v_lshl_add_u32 v4, v5, 2, v4
  v_add_u32 v204, 139392, v4
  s_waitcnt vmcnt(20)
  v_add_u32 v255, 131072, v4
  v_lshl_add_u32 v5, v6, 11, v17
  v_lshrrev_b32 v7, 1, v6
  v_lshl_add_u32 v5, v7, 6, v5
  v_add_u32 v254, 139392, v5
  v_lshlrev_b32 v4, 10, v3
  v_lshl_add_u32 v4, v2, 4, v4
  v_lshl_add_u32 v4, v6, 2, v4
  v_add_u32 v55, 155648, v4
  v_lshl_add_u32 v4, v3, 2, v207
  v_bfe_u32 v5, v4, 1, 2
  v_lshlrev_b32 v4, 7, v4
  s_add_u32 m0, s3, 160512
  s_nop 0
  buffer_load_dword v205, s[8:11], s52 offen lds
  v_lshl_add_u32 v4, v5, 5, v4
  v_lshl_add_u32 v4, v206, 3, v4
  s_and_b32 s58, s40, 1
  s_lshl_b32 s58, s58, 6
  s_lshr_b32 s59, s40, 1
  s_lshl_b32 s59, s59, 12
  s_add_u32 s58, s58, s59
  v_xor_b32 v26, s58, v4
  v_xor_b32 v27, 32, v26
  v_add_u32 v28, 0x10000, v26
  v_add_u32 v29, 0x10000, v27
  v_add_u32 v22, s47, v4
  v_xor_b32 v23, 32, v22
  v_xor_b32 v24, 64, v22
  v_xor_b32 v25, 96, v22
  v_lshl_add_u32 v4, v6, 10, v17
  v_add_u32 v54, 131072, v4
  v_bfe_u32 v5, v0, 4, 3
  v_lshlrev_b32 v5, 18, v5
  v_bfe_u32 v7, v0, 3, 1
  v_lshl_add_u32 v5, v7, 9, v5
  v_and_b32 v7, 0x80, v0
  v_add_u32 v5, v5, v7
  v_and_b32 v7, 7, v0
  v_lshl_add_u32 v5, v7, 4, v5
  v_xor_b32 v52, s56, v5
  v_xor_b32 v53, 0x100, v52
  s_mov_b32 s58, 0x3e000000
  v_and_b32 v4, 1, v2
  v_lshl_add_u32 v4, v6, 1, v4
  v_cvt_f32_u32 v4, v4
  v_mul_f32 v4, s58, v4
  v_lshrrev_b32 v5, 1, v2
  v_and_b32 v7, 1, v5
  v_lshlrev_b32 v7, 15, v7
  v_lshl_or_b32 v7, v7, 16, v7
  v_cvt_f32_u32 v5, v5
  v_mul_f32 v5, s58, v5
  v_mul_f32 v220, v31, v4
  v_add_f32 v220, v220, v220
  v_add_f32 v221, v220, v4
  v_add_f32 v220, v220, v5
  v_add_f32 v221, v221, v5
  v_cos_f32 v222, v220
  v_sin_f32 v223, v220
  v_cos_f32 v224, v221
  v_sin_f32 v225, v221
  v_cvt_pk_bf16_f32 v112, v222, -v223
  v_cvt_pk_bf16_f32 v113, v224, -v225
  v_add_f32 v220, v220, v5
  v_add_f32 v221, v221, v5
  v_cos_f32 v222, v220
  v_sin_f32 v223, v220
  v_cos_f32 v224, v221
  v_sin_f32 v225, v221
  v_cvt_pk_bf16_f32 v114, v222, -v223
  v_cvt_pk_bf16_f32 v115, v224, -v225
  v_add_f32 v220, v220, v5
  v_add_f32 v221, v221, v5
  v_cos_f32 v222, v220
  v_sin_f32 v223, v220
  v_cos_f32 v224, v221
  v_sin_f32 v225, v221
  v_cvt_pk_bf16_f32 v116, v222, -v223
  v_cvt_pk_bf16_f32 v117, v224, -v225
  v_add_f32 v220, v220, v5
  v_add_f32 v221, v221, v5
  v_cos_f32 v222, v220
  v_sin_f32 v223, v220
  v_cos_f32 v224, v221
  v_sin_f32 v225, v221
  v_cvt_pk_bf16_f32 v118, v222, -v223
  v_cvt_pk_bf16_f32 v119, v224, -v225
  v_xor_b32 v120, v7, v112
  v_xor_b32 v121, v7, v113
  v_xor_b32 v122, v7, v114
  v_xor_b32 v123, v7, v115
  v_xor_b32 v124, v7, v116
  v_xor_b32 v125, v7, v117
  v_xor_b32 v126, v7, v118
  v_xor_b32 v127, v7, v119
  s_waitcnt vmcnt(12)
  s_waitcnt lgkmcnt(0)
  s_barrier
  v_and_b32 v16, 0x1f0, v17
  s_lshl_b32 s58, s41, 9
  s_add_u32 s54, s58, 4194304
  buffer_load_dwordx3 v[12:14], v16, s[32:35], s54 offen sc1
  ds_read_b64_tr_b16 a[0:1], v26 offset:0
  ds_read_b64_tr_b16 a[2:3], v26 offset:2048
  ds_read_b64_tr_b16 a[4:5], v26 offset:8192
  ds_read_b64_tr_b16 a[6:7], v26 offset:10240
  ds_read_b64_tr_b16 a[8:9], v27 offset:0
  ds_read_b64_tr_b16 a[10:11], v27 offset:2048
  ds_read_b64_tr_b16 a[12:13], v27 offset:8192
  ds_read_b64_tr_b16 a[14:15], v27 offset:10240
  s_add_u32 m0, s47, 16384
  s_nop 0
  buffer_load_dwordx4 v20, s[24:27], s62 offen offset:2048 lds
  buffer_load_dwordx4 v21, s[24:27], s62 offen offset:3072 lds
  s_add_u32 m0, s47, 32768
  s_add_u32 s62, s62, s63
  buffer_load_dwordx4 v18, s[24:27], s62 offen offset:0 lds
  buffer_load_dwordx4 v19, s[24:27], s62 offen offset:1024 lds
  s_waitcnt vmcnt(9)
L_x1:
  v_xor_b32 v56, v200, v56
  v_xor_b32 v57, v201, v57
  v_xor_b32 v58, v202, v58
  v_xor_b32 v59, v203, v59
  v_xor_b32 v60, v200, v60
  v_xor_b32 v61, v201, v61
  v_xor_b32 v62, v202, v62
  v_xor_b32 v63, v203, v63
  v_or3_b32 v4, v56, v57, v58
  v_or3_b32 v5, v59, v60, v61
  v_or3_b32 v4, v4, v62, v63
  v_bitop3_b32 v4, v4, v5, s55 bitop3:0xa8
  v_cmp_ne_u32 vcc, 0, v4
  ds_write2st64_b32 v204, v56, v57 offset0:0 offset1:4
  ds_write2st64_b32 v204, v58, v59 offset0:8 offset1:12
  ds_write2st64_b32 v204, v60, v61 offset0:2 offset1:6
  ds_write2st64_b32 v204, v62, v63 offset0:10 offset1:14
  s_cbranch_vccnz L_x1_re
  s_waitcnt lgkmcnt(0)
  s_barrier
  ds_read_b128 v[56:59], v254
  buffer_load_dwordx4 v20, s[24:27], s62 offen offset:2048 lds
  ds_read_b128 v[60:63], v254 offset:1024
  s_waitcnt lgkmcnt(1)
  v_mfma_f32_16x16x32_f16 v[80:83], v[56:59], v[136:139], 0
  v_mfma_f32_16x16x32_f16 v[84:87], v[56:59], v[140:143], 0
  s_waitcnt lgkmcnt(0)
  v_mfma_f32_16x16x32_f16 v[88:91], v[60:63], v[136:139], 0
  buffer_load_dwordx4 v21, s[24:27], s62 offen offset:3072 lds
  v_mfma_f32_16x16x32_f16 v[92:95], v[60:63], v[140:143], 0
  s_waitcnt vmcnt(7)
  s_barrier
  ds_read2st64_b32 v[128:129], v55 offset0:0 offset1:1
  ds_read2st64_b32 v[130:131], v55 offset0:2 offset1:3
  ds_read2st64_b32 v[132:133], v55 offset0:16 offset1:17
  ds_read2st64_b32 v[134:135], v55 offset0:18 offset1:19
  s_waitcnt vmcnt(6)
L_pl:
  v_cmp_ne_u64 vcc, s[48:49], v[12:13]
  s_cbranch_vccnz L_pl_re
  v_cmp_ne_u32 vcc, s46, v14
  v_lshlrev_b32 v16, 3, v1
  v_min_u32 v16, 48, v16
  s_cmp_eq_u64 vcc, 0
  s_cselect_b32 s44, 1, 0
  v_pk_mul_f32 v[212:213], v[80:81], v[72:73]
  s_add_u32 m0, s47, 49152
  s_add_u32 s62, s62, s63
  buffer_load_dwordx4 v18, s[24:27], s62 offen offset:0 lds
  v_pk_mul_f32 v[216:217], v[80:81], v[76:77]
  v_pk_mul_f32 v[214:215], v[82:83], v[74:75]
  v_pk_mul_f32 v[218:219], v[82:83], v[78:79]
  v_pk_fma_f32 v[212:213], v[84:85], v[76:77], v[212:213] neg_lo:[1,0,0] neg_hi:[1,0,0]
  v_pk_fma_f32 v[216:217], v[84:85], v[72:73], v[216:217]
  v_pk_fma_f32 v[214:215], v[86:87], v[78:79], v[214:215] neg_lo:[1,0,0] neg_hi:[1,0,0]
  v_pk_fma_f32 v[218:219], v[86:87], v[74:75], v[218:219]
  v_pk_mul_f32 v[220:221], v[88:89], v[72:73]
  v_pk_mul_f32 v[224:225], v[88:89], v[76:77]
  v_pk_mul_f32 v[222:223], v[90:91], v[74:75]
  v_pk_mul_f32 v[226:227], v[90:91], v[78:79]
  v_pk_fma_f32 v[220:221], v[92:93], v[76:77], v[220:221] neg_lo:[1,0,0] neg_hi:[1,0,0]
  v_pk_fma_f32 v[224:225], v[92:93], v[72:73], v[224:225]
  v_pk_fma_f32 v[222:223], v[94:95], v[78:79], v[222:223] neg_lo:[1,0,0] neg_hi:[1,0,0]
  v_pk_fma_f32 v[226:227], v[94:95], v[74:75], v[226:227]
  v_cvt_pk_f16_f32 v56, v212, v216
  v_cvt_pk_f16_f32 v57, v213, v217
  v_cvt_pk_f16_f32 v58, v214, v218
  v_cvt_pk_f16_f32 v59, v215, v219
  v_cvt_pk_f16_f32 v60, v220, v224
  buffer_load_dwordx4 v19, s[24:27], s62 offen offset:1024 lds
  v_cvt_pk_f16_f32 v61, v221, v225
  v_mfma_f32_16x16x32_f16 v[80:83], v[144:147], v[56:59], 0
  v_cvt_pk_f16_f32 v62, v222, v226
  v_cvt_pk_f16_f32 v63, v223, v227
  v_mfma_f32_16x16x32_f16 v[84:87], v[148:151], v[56:59], 0
  s_waitcnt lgkmcnt(3)
  v_lshlrev_b32 v228, 16, v128
  v_lshlrev_b32 v229, 16, v129
  v_mfma_f32_16x16x32_f16 v[88:91], v[144:147], v[60:63], 0
  s_waitcnt lgkmcnt(2)
  v_lshlrev_b32 v230, 16, v130
  v_lshlrev_b32 v231, 16, v131
  v_mfma_f32_16x16x32_f16 v[92:95], v[148:151], v[60:63], 0
  s_waitcnt lgkmcnt(1)
  v_lshlrev_b32 v232, 16, v132
  v_lshlrev_b32 v233, 16, v133
  buffer_load_dwordx4 v20, s[24:27], s62 offen offset:2048 lds
  s_waitcnt lgkmcnt(0)
  v_lshlrev_b32 v234, 16, v134
  v_lshlrev_b32 v235, 16, v135
  v_and_b32 v236, s57, v128
  v_and_b32 v237, s57, v129
  v_and_b32 v238, s57, v130
  buffer_load_dwordx4 v21, s[24:27], s62 offen offset:3072 lds
  v_and_b32 v239, s57, v131
  v_and_b32 v240, s57, v132
  v_and_b32 v241, s57, v133
  v_and_b32 v242, s57, v134
  v_and_b32 v243, s57, v135
  v_pk_mul_f32 v[212:213], v[80:81], v[228:229]
  v_pk_mul_f32 v[216:217], v[80:81], v[232:233]
  v_pk_mul_f32 v[214:215], v[82:83], v[230:231]
  v_pk_mul_f32 v[218:219], v[82:83], v[234:235]
  v_pk_fma_f32 v[212:213], v[84:85], v[232:233], v[212:213] neg_lo:[1,0,0] neg_hi:[1,0,0]
  v_pk_fma_f32 v[216:217], v[84:85], v[228:229], v[216:217]
  v_pk_fma_f32 v[214:215], v[86:87], v[234:235], v[214:215] neg_lo:[1,0,0] neg_hi:[1,0,0]
  v_pk_fma_f32 v[218:219], v[86:87], v[230:231], v[218:219]
  v_pk_mul_f32 v[220:221], v[88:89], v[236:237]
  v_pk_mul_f32 v[224:225], v[88:89], v[240:241]
  v_pk_mul_f32 v[222:223], v[90:91], v[238:239]
  v_pk_mul_f32 v[226:227], v[90:91], v[242:243]
  v_pk_fma_f32 v[220:221], v[92:93], v[240:241], v[220:221] neg_lo:[1,0,0] neg_hi:[1,0,0]
  v_pk_fma_f32 v[224:225], v[92:93], v[236:237], v[224:225]
  v_pk_fma_f32 v[222:223], v[94:95], v[242:243], v[222:223] neg_lo:[1,0,0] neg_hi:[1,0,0]
  s_add_u32 m0, s47, 65536
  s_add_u32 s62, s62, s63
  buffer_load_dwordx4 v18, s[24:27], s62 offen offset:0 lds
  v_pk_fma_f32 v[226:227], v[94:95], v[238:239], v[226:227]
  v_cvt_pk_bf16_f32 v56, v212, v216
  v_cvt_pk_bf16_f32 v57, v213, v217
  v_cvt_pk_bf16_f32 v58, v214, v218
  v_cvt_pk_bf16_f32 v59, v215, v219
  v_cvt_pk_bf16_f32 v60, v220, v224
  v_cvt_pk_bf16_f32 v61, v221, v225
  v_mfma_f32_16x16x32_bf16 v[80:83], v[56:59], v[152:155], 0
  v_cvt_pk_bf16_f32 v62, v222, v226
  v_cvt_pk_bf16_f32 v63, v223, v227
  v_mfma_f32_16x16x32_bf16 v[84:87], v[56:59], v[156:159], 0
  s_nop 0
  v_mfma_f32_16x16x32_bf16 v[88:91], v[60:63], v[152:155], 0
  v_mfma_f32_16x16x32_bf16 v[92:95], v[60:63], v[156:159], 0
  buffer_load_dwordx4 v19, s[24:27], s62 offen offset:1024 lds
  s_mov_b32 exec_lo, 0x0f0f0f0f
  s_mov_b32 exec_hi, 0x0f0f0f0f
  s_cmp_eq_u32 s44, 0
  s_cbranch_scc1 L_slow0
  buffer_store_dwordx4 v[208:211], v252, s[32:35], s50 offen
  buffer_store_dwordx4 v[208:211], v252, s[32:35], s53 offen
L_back0:
  s_mov_b64 exec, -1
  v_pk_mul_f32 v[212:213], v[80:81], v[64:65]
  v_pk_mul_f32 v[216:217], v[80:81], v[68:69]
  v_pk_mul_f32 v[214:215], v[82:83], v[66:67]
  v_pk_mul_f32 v[218:219], v[82:83], v[70:71]
  v_pk_fma_f32 v[212:213], v[84:85], v[68:69], v[212:213] neg_lo:[1,0,0] neg_hi:[1,0,0]
  v_pk_fma_f32 v[216:217], v[84:85], v[64:65], v[216:217]
  v_pk_fma_f32 v[214:215], v[86:87], v[70:71], v[214:215] neg_lo:[1,0,0] neg_hi:[1,0,0]
  v_pk_fma_f32 v[218:219], v[86:87], v[66:67], v[218:219]
  v_pk_mul_f32 v[220:221], v[88:89], v[64:65]
  v_pk_mul_f32 v[224:225], v[88:89], v[68:69]
  v_pk_mul_f32 v[222:223], v[90:91], v[66:67]
  v_pk_mul_f32 v[226:227], v[90:91], v[70:71]
  v_pk_fma_f32 v[220:221], v[92:93], v[68:69], v[220:221] neg_lo:[1,0,0] neg_hi:[1,0,0]
  buffer_load_dwordx4 v20, s[24:27], s62 offen offset:2048 lds
  v_pk_fma_f32 v[224:225], v[92:93], v[64:65], v[224:225]
  v_pk_fma_f32 v[222:223], v[94:95], v[70:71], v[222:223] neg_lo:[1,0,0] neg_hi:[1,0,0]
  v_pk_fma_f32 v[226:227], v[94:95], v[66:67], v[226:227]
  v_cvt_pk_bf16_f32 v56, v212, v216
  v_cvt_pk_bf16_f32 v57, v213, v217
  v_cvt_pk_bf16_f32 v58, v214, v218
  v_cvt_pk_bf16_f32 v59, v215, v219
  v_cvt_pk_bf16_f32 v60, v220, v224
  v_cvt_pk_bf16_f32 v61, v221, v225
  v_cvt_pk_bf16_f32 v62, v222, v226
  v_cvt_pk_bf16_f32 v63, v223, v227
  v_mfma_f32_16x16x32_bf16 v[80:83], v[56:59], v[160:163], 0
  s_lshl_b32 s0, s43, 7
  s_lshl_b32 s1, s40, 5
  s_add_u32 s0, s0, s1
  v_mfma_f32_16x16x32_bf16 v[88:91], v[60:63], v[160:163], 0
  s_add_u32 s52, s0, 4259840
  s_lshl2_add_u32 s0, s43, s40
  s_lshl_b32 s53, s0, 11
  v_mfma_f32_16x16x32_bf16 v[84:87], v[56:59], v[164:167], 0
  buffer_load_dwordx4 v21, s[24:27], s62 offen offset:3072 lds
  s_and_b32 s0, s42, 1
  s_bfe_u32 s1, s42, 0x10001
  s_lshl1_add_u32 s0, s0, s1
  v_mfma_f32_16x16x32_bf16 v[92:95], v[60:63], v[164:167], 0
  s_lshl2_add_u32 s50, s41, s0
  s_xor_b32 s55, s50, 1
  s_mov_b32 s0, 0
  s_waitcnt vmcnt(6)
  v_cvt_pk_bf16_f32 v212, v80, v88
  v_cvt_pk_bf16_f32 v213, v81, v89
  v_cvt_pk_bf16_f32 v214, v82, v90
  v_cvt_pk_bf16_f32 v215, v83, v91
  v_min_u32 v212, -2, v212
  v_min_u32 v213, -2, v213
  v_min_u32 v214, -2, v214
  v_min_u32 v215, -2, v215
  ds_write_b128 v54, v[212:215] offset:0
  v_cvt_pk_bf16_f32 v216, v84, v92
  v_cvt_pk_bf16_f32 v217, v85, v93
  s_add_u32 m0, s47, 81920
  s_add_u32 s62, s62, s63
  buffer_load_dwordx4 v18, s[24:27], s62 offen offset:0 lds
  v_cvt_pk_bf16_f32 v218, v86, v94
  v_cvt_pk_bf16_f32 v219, v87, v95
  v_min_u32 v216, -2, v216
  v_min_u32 v217, -2, v217
  v_min_u32 v218, -2, v218
  v_min_u32 v219, -2, v219
  ds_write_b128 v54, v[216:219] offset:4160
  s_add_u32 s0, s0, s40
  s_and_b32 s0, s0, 3
  s_lshl_b32 s0, s0, 9
  s_lshl_b32 s1, s50, 10
  s_add_u32 s22, s1, 4259840
  s_lshl_b32 s1, s50, 16
  s_add_u32 s66, s1, s0
  s_lshl_b32 s1, s55, 10
  s_add_u32 s23, s1, 4259840
  s_lshl_b32 s1, s55, 16
  s_waitcnt vmcnt(3)
  s_waitcnt lgkmcnt(0)
  s_barrier
  ds_read2st64_b32 v[56:57], v255 offset0:0 offset1:4
  buffer_load_dwordx4 v19, s[24:27], s62 offen offset:1024 lds
  ds_read2st64_b32 v[58:59], v255 offset0:8 offset1:12
  ds_read2st64_b32 v[60:61], v255 offset0:2 offset1:6
  ds_read2st64_b32 v[62:63], v255 offset0:10 offset1:14
  s_add_u32 s67, s1, s0
  s_mov_b32 s36, s18
  s_mov_b32 s37, s19
  s_mov_b32 s38, 2097152
  s_mov_b32 s39, 0x20000
  s_lshr_b32 s0, s42, 2
  s_lshr_b32 s1, s47, 2
  s_add_u32 s14, s1, 4325376
  s_lshl3_add_u32 s1, s0, s14
  s_lshl_b32 s12, s50, 12
  s_waitcnt lgkmcnt(2)
  buffer_store_dwordx4 v[56:59], v52, s[32:35], s51 offen sc1
  s_waitcnt lgkmcnt(0)
  buffer_store_dwordx4 v[60:63], v53, s[32:35], s51 offen sc1
  s_lshl_b32 s58, s41, 18
  s_add_u32 s51, s58, 2097152
  ds_read_b64_tr_b16 a[16:17], v26 offset:16384
  buffer_load_dwordx4 v20, s[24:27], s62 offen offset:2048 lds
  ds_read_b64_tr_b16 a[18:19], v26 offset:18432
  ds_read_b64_tr_b16 a[20:21], v26 offset:24576
  ds_read_b64_tr_b16 a[22:23], v26 offset:26624
  ds_read_b64_tr_b16 a[24:25], v27 offset:16384
  ds_read_b64_tr_b16 a[26:27], v27 offset:18432
  ds_read_b64_tr_b16 a[28:29], v27 offset:24576
  ds_read_b64_tr_b16 a[30:31], v27 offset:26624
  ds_read_b64_tr_b16 a[32:33], v26 offset:32768
  ds_read_b64_tr_b16 a[34:35], v26 offset:34816
  ds_read_b64_tr_b16 a[36:37], v26 offset:40960
  ds_read_b64_tr_b16 a[38:39], v26 offset:43008
  ds_read_b64_tr_b16 a[40:41], v27 offset:32768
  ds_read_b64_tr_b16 a[42:43], v27 offset:34816
  ds_read_b64_tr_b16 a[44:45], v27 offset:40960
  ds_read_b64_tr_b16 a[46:47], v27 offset:43008
  ds_read_b64_tr_b16 a[48:49], v26 offset:49152
  ds_read_b64_tr_b16 a[50:51], v26 offset:51200
  ds_read_b64_tr_b16 a[52:53], v26 offset:57344
  ds_read_b64_tr_b16 a[54:55], v26 offset:59392
  ds_read_b64_tr_b16 a[56:57], v27 offset:49152
  buffer_load_dwordx4 v21, s[24:27], s62 offen offset:3072 lds
  ds_read_b64_tr_b16 a[58:59], v27 offset:51200
  ds_read_b64_tr_b16 a[60:61], v27 offset:57344
  ds_read_b64_tr_b16 a[62:63], v27 offset:59392
  v_lshrrev_b32 v7, 1, v2
  v_lshlrev_b32 v4, 4, v7
  v_lshl_add_u32 v4, v6, 2, v4
  v_add_u32 v4, v4, v3
  v_and_b32 v5, 1, v2
  v_lshlrev_b32 v5, 4, v5
  v_lshl_add_u32 v5, v3, 8, v5
  s_and_b32 s58, s42, 1
  s_lshl2_add_u32 s58, s58, s40
  s_and_b32 s58, s58, 6
  s_lshr_b32 s58, 0x78, s58
  s_and_b32 s58, s58, 3
  v_xor_b32 v252, s58, v3
  v_lshlrev_b32 v7, 8, v7
  v_lshl_add_u32 v7, v252, 5, v7
  v_and_or_b32 v252, v5, 16, v7
  s_lshl_b32 s59, s42, 5
  v_xor_b32 v5, s59, v5
  s_add_u32 m0, s47, 98304
  s_add_u32 s62, s62, s63
  buffer_load_dwordx4 v18, s[24:27], s62 offen offset:0 lds
  v_lshl_add_u32 v254, v4, 11, v5
  v_xor_b32 v255, 0x480, v254
  v_add_u32 v211, 147456, v17
  v_add_u32 v210, s47, v211
  v_xor_b32 v253, 0x80008000, v253
  v_lshl_add_u32 v4, v207, 3, v206
  v_cvt_f32_u32 v4, v4
  v_lshlrev_b32 v5, 6, v3
  v_lshl_add_u32 v5, v6, 1, v5
  v_cmp_eq_u32 vcc, 0xc6, v5
  v_add_u32 v5, 1, v5
  v_cvt_f32_u32 v5, v5
  v_mov_b32 v201, 0.5
  v_cndmask_b32 v201, 1.0, v201, vcc
  s_mov_b32 s58, 0x3b000000
  s_mov_b32 s59, 0x41000000
  v_add_f32 v7, 0x00000000, v4
  v_mul_f32 v7, s58, v7
  v_mul_f32 v202, s59, v7
  v_mul_f32 v72, v7, v5
  buffer_load_dwordx4 v19, s[24:27], s62 offen offset:1024 lds
  v_add_f32 v73, v72, v7
  v_add_f32 v7, 0x40800000, v4
  v_mul_f32 v7, s58, v7
  v_mul_f32 v203, s59, v7
  v_mul_f32 v74, v7, v5
  v_add_f32 v75, v74, v7
  v_add_f32 v7, 0x42000000, v4
  v_mul_f32 v7, s58, v7
  v_mul_f32 v204, s59, v7
  v_mul_f32 v76, v7, v5
  v_add_f32 v77, v76, v7
  v_add_f32 v7, 0x42100000, v4
  v_mul_f32 v7, s58, v7
  v_mul_f32 v205, s59, v7
  v_mul_f32 v78, v7, v5
  v_add_f32 v79, v78, v7
  v_add_f32 v83, v72, v202
  v_cos_f32 v220, v202
  v_cos_f32 v80, v72
  buffer_load_dwordx4 v20, s[24:27], s62 offen offset:2048 lds
  v_sin_f32 v81, v72
  v_cos_f32 v82, v83
  v_sin_f32 v83, v83
  v_add_f32 v87, v73, v202
  v_cos_f32 v84, v73
  v_sin_f32 v85, v73
  v_cos_f32 v86, v87
  v_sin_f32 v87, v87
  v_add_f32 v91, v74, v203
  v_cos_f32 v224, v203
  v_cos_f32 v88, v74
  buffer_load_dwordx4 v21, s[24:27], s62 offen offset:3072 lds
  v_sin_f32 v89, v74
  v_cos_f32 v90, v91
  v_sin_f32 v91, v91
  v_add_f32 v95, v75, v203
  v_cos_f32 v92, v75
  v_sin_f32 v93, v75
  v_cos_f32 v94, v95
  v_sin_f32 v95, v95
  s_mov_b32 s58, 0x3a000000
  v_add_f32 v220, v220, v220
  v_add_f32 v224, v224, v224
  v_pk_mul_f32 v[80:81], v[80:81], s[58:59] op_sel_hi:[1,0]
  v_pk_mul_f32 v[82:83], v[82:83], s[58:59] op_sel_hi:[1,0]
  s_add_u32 m0, s47, 114688
  s_add_u32 s62, s62, s63
  buffer_load_dwordx4 v18, s[24:27], s62 offen offset:0 lds
  v_pk_mul_f32 v[84:85], v[84:85], s[58:59] op_sel_hi:[1,0]
  v_pk_mul_f32 v[86:87], v[86:87], s[58:59] op_sel_hi:[1,0]
  v_pk_mul_f32 v[88:89], v[88:89], s[58:59] op_sel_hi:[1,0]
  v_pk_mul_f32 v[90:91], v[90:91], s[58:59] op_sel_hi:[1,0]
  v_pk_mul_f32 v[92:93], v[92:93], s[58:59] op_sel_hi:[1,0]
  v_pk_mul_f32 v[94:95], v[94:95], s[58:59] op_sel_hi:[1,0]
  v_cvt_pk_bf16_f32 v168, v80, v82
  v_cvt_pk_bf16_f32 v172, v81, v83
  v_cvt_pk_bf16_f32 v176, v84, v86
  v_cvt_pk_bf16_f32 v180, v85, v87
  v_cvt_pk_bf16_f32 v184, v88, v90
  v_cvt_pk_bf16_f32 v188, v89, v91
  v_cvt_pk_bf16_f32 v192, v92, v94
  v_cvt_pk_bf16_f32 v196, v93, v95
  v_pk_fma_f32 v[80:81], v[82:83], v[220:221], v[80:81] op_sel_hi:[1,0,1] neg_lo:[0,0,1] neg_hi:[0,0,1]
  v_pk_fma_f32 v[84:85], v[86:87], v[220:221], v[84:85] op_sel_hi:[1,0,1] neg_lo:[0,0,1] neg_hi:[0,0,1]
  v_pk_fma_f32 v[88:89], v[90:91], v[224:225], v[88:89] op_sel_hi:[1,0,1] neg_lo:[0,0,1] neg_hi:[0,0,1]
  v_pk_fma_f32 v[92:93], v[94:95], v[224:225], v[92:93] op_sel_hi:[1,0,1] neg_lo:[0,0,1] neg_hi:[0,0,1]
  v_pk_fma_f32 v[82:83], v[80:81], v[220:221], v[82:83] op_sel_hi:[1,0,1] neg_lo:[0,0,1] neg_hi:[0,0,1]
  v_pk_fma_f32 v[86:87], v[84:85], v[220:221], v[86:87] op_sel_hi:[1,0,1] neg_lo:[0,0,1] neg_hi:[0,0,1]
  buffer_load_dwordx4 v19, s[24:27], s62 offen offset:1024 lds
  v_pk_fma_f32 v[90:91], v[88:89], v[224:225], v[90:91] op_sel_hi:[1,0,1] neg_lo:[0,0,1] neg_hi:[0,0,1]
  v_pk_fma_f32 v[94:95], v[92:93], v[224:225], v[94:95] op_sel_hi:[1,0,1] neg_lo:[0,0,1] neg_hi:[0,0,1]
  v_cvt_pk_bf16_f32 v169, v80, v82
  v_cvt_pk_bf16_f32 v173, v81, v83
  v_cvt_pk_bf16_f32 v177, v84, v86
  v_cvt_pk_bf16_f32 v181, v85, v87
  v_cvt_pk_bf16_f32 v185, v88, v90
  v_cvt_pk_bf16_f32 v189, v89, v91
  v_cvt_pk_bf16_f32 v193, v92, v94
  v_cvt_pk_bf16_f32 v197, v93, v95
  v_pk_fma_f32 v[80:81], v[82:83], v[220:221], v[80:81] op_sel_hi:[1,0,1] neg_lo:[0,0,1] neg_hi:[0,0,1]
  v_pk_fma_f32 v[84:85], v[86:87], v[220:221], v[84:85] op_sel_hi:[1,0,1] neg_lo:[0,0,1] neg_hi:[0,0,1]
  v_pk_fma_f32 v[88:89], v[90:91], v[224:225], v[88:89] op_sel_hi:[1,0,1] neg_lo:[0,0,1] neg_hi:[0,0,1]
  v_pk_fma_f32 v[92:93], v[94:95], v[224:225], v[92:93] op_sel_hi:[1,0,1] neg_lo:[0,0,1] neg_hi:[0,0,1]
  v_pk_fma_f32 v[82:83], v[80:81], v[220:221], v[82:83] op_sel_hi:[1,0,1] neg_lo:[0,0,1] neg_hi:[0,0,1]
  v_pk_fma_f32 v[86:87], v[84:85], v[220:221], v[86:87] op_sel_hi:[1,0,1] neg_lo:[0,0,1] neg_hi:[0,0,1]
  v_pk_fma_f32 v[90:91], v[88:89], v[224:225], v[90:91] op_sel_hi:[1,0,1] neg_lo:[0,0,1] neg_hi:[0,0,1]
  v_pk_fma_f32 v[94:95], v[92:93], v[224:225], v[94:95] op_sel_hi:[1,0,1] neg_lo:[0,0,1] neg_hi:[0,0,1]
  v_cvt_pk_bf16_f32 v170, v80, v82
  v_cvt_pk_bf16_f32 v174, v81, v83
  buffer_load_dwordx4 v20, s[24:27], s62 offen offset:2048 lds
  v_cvt_pk_bf16_f32 v178, v84, v86
  v_cvt_pk_bf16_f32 v182, v85, v87
  v_cvt_pk_bf16_f32 v186, v88, v90
  v_cvt_pk_bf16_f32 v190, v89, v91
  v_cvt_pk_bf16_f32 v194, v92, v94
  v_cvt_pk_bf16_f32 v198, v93, v95
  v_pk_fma_f32 v[80:81], v[82:83], v[220:221], v[80:81] op_sel_hi:[1,0,1] neg_lo:[0,0,1] neg_hi:[0,0,1]
  v_pk_fma_f32 v[84:85], v[86:87], v[220:221], v[84:85] op_sel_hi:[1,0,1] neg_lo:[0,0,1] neg_hi:[0,0,1]
  v_pk_fma_f32 v[88:89], v[90:91], v[224:225], v[88:89] op_sel_hi:[1,0,1] neg_lo:[0,0,1] neg_hi:[0,0,1]
  v_pk_fma_f32 v[92:93], v[94:95], v[224:225], v[92:93] op_sel_hi:[1,0,1] neg_lo:[0,0,1] neg_hi:[0,0,1]
L_page2:
  s_cbranch_execz L_hop123
  v_pk_fma_f32 v[82:83], v[80:81], v[220:221], v[82:83] op_sel_hi:[1,0,1] neg_lo:[0,0,1] neg_hi:[0,0,1]
  v_pk_fma_f32 v[86:87], v[84:85], v[220:221], v[86:87] op_sel_hi:[1,0,1] neg_lo:[0,0,1] neg_hi:[0,0,1]
  v_pk_fma_f32 v[90:91], v[88:89], v[224:225], v[90:91] op_sel_hi:[1,0,1] neg_lo:[0,0,1] neg_hi:[0,0,1]
  v_pk_fma_f32 v[94:95], v[92:93], v[224:225], v[94:95] op_sel_hi:[1,0,1] neg_lo:[0,0,1] neg_hi:[0,0,1]
  v_cvt_pk_bf16_f32 v171, v80, v82
  v_cvt_pk_bf16_f32 v175, v81, v83
  v_mul_f32 v86, v86, v201
  v_cvt_pk_bf16_f32 v179, v84, v86
  v_cvt_pk_bf16_f32 v183, v85, v87
  v_cvt_pk_bf16_f32 v187, v88, v90
  buffer_load_dwordx4 v21, s[24:27], s62 offen offset:3072 lds
  v_cvt_pk_bf16_f32 v191, v89, v91
  v_mul_f32 v94, v94, v201
  v_cvt_pk_bf16_f32 v195, v92, v94
  v_cvt_pk_bf16_f32 v199, v93, v95
  v_add_f32 v83, v76, v204
  v_cos_f32 v220, v204
  v_cos_f32 v80, v76
  v_sin_f32 v81, v76
  v_cos_f32 v82, v83
  v_sin_f32 v83, v83
  v_add_f32 v87, v77, v204
  v_cos_f32 v84, v77
  v_sin_f32 v85, v77
  s_add_u32 m0, s47, 0
  s_add_u32 s62, s62, s63
  buffer_load_dwordx4 v18, s[24:27], s62 offen offset:0 lds
  v_cos_f32 v86, v87
  v_sin_f32 v87, v87
  v_add_f32 v91, v78, v205
  v_cos_f32 v224, v205
  v_cos_f32 v88, v78
  v_sin_f32 v89, v78
  v_cos_f32 v90, v91
  v_sin_f32 v91, v91
  v_add_f32 v95, v79, v205
  v_cos_f32 v92, v79
  v_sin_f32 v93, v79
  buffer_load_dwordx4 v19, s[24:27], s62 offen offset:1024 lds
  v_cos_f32 v94, v95
  v_sin_f32 v95, v95
  s_mov_b32 s58, 0x3a000000
  v_add_f32 v220, v220, v220
  v_add_f32 v224, v224, v224
  v_pk_mul_f32 v[80:81], v[80:81], s[58:59] op_sel_hi:[1,0]
  v_pk_mul_f32 v[82:83], v[82:83], s[58:59] op_sel_hi:[1,0]
  v_pk_mul_f32 v[84:85], v[84:85], s[58:59] op_sel_hi:[1,0]
  v_pk_mul_f32 v[86:87], v[86:87], s[58:59] op_sel_hi:[1,0]
  v_pk_mul_f32 v[88:89], v[88:89], s[58:59] op_sel_hi:[1,0]
  v_pk_mul_f32 v[90:91], v[90:91], s[58:59] op_sel_hi:[1,0]
  v_pk_mul_f32 v[92:93], v[92:93], s[58:59] op_sel_hi:[1,0]
  v_pk_mul_f32 v[94:95], v[94:95], s[58:59] op_sel_hi:[1,0]
  v_cvt_pk_bf16_f32 v128, v80, v82
  v_cvt_pk_bf16_f32 v132, v81, v83
  v_cvt_pk_bf16_f32 v136, v84, v86
  v_cvt_pk_bf16_f32 v140, v85, v87
  v_cvt_pk_bf16_f32 v144, v88, v90
  buffer_load_dwordx4 v20, s[24:27], s62 offen offset:2048 lds
  v_cvt_pk_bf16_f32 v148, v89, v91
  v_cvt_pk_bf16_f32 v152, v92, v94
  v_cvt_pk_bf16_f32 v156, v93, v95
  v_pk_fma_f32 v[80:81], v[82:83], v[220:221], v[80:81] op_sel_hi:[1,0,1] neg_lo:[0,0,1] neg_hi:[0,0,1]
  v_pk_fma_f32 v[84:85], v[86:87], v[220:221], v[84:85] op_sel_hi:[1,0,1] neg_lo:[0,0,1] neg_hi:[0,0,1]
  v_pk_fma_f32 v[88:89], v[90:91], v[224:225], v[88:89] op_sel_hi:[1,0,1] neg_lo:[0,0,1] neg_hi:[0,0,1]
  v_pk_fma_f32 v[92:93], v[94:95], v[224:225], v[92:93] op_sel_hi:[1,0,1] neg_lo:[0,0,1] neg_hi:[0,0,1]
  v_pk_fma_f32 v[82:83], v[80:81], v[220:221], v[82:83] op_sel_hi:[1,0,1] neg_lo:[0,0,1] neg_hi:[0,0,1]
  v_pk_fma_f32 v[86:87], v[84:85], v[220:221], v[86:87] op_sel_hi:[1,0,1] neg_lo:[0,0,1] neg_hi:[0,0,1]
  v_pk_fma_f32 v[90:91], v[88:89], v[224:225], v[90:91] op_sel_hi:[1,0,1] neg_lo:[0,0,1] neg_hi:[0,0,1]
  v_pk_fma_f32 v[94:95], v[92:93], v[224:225], v[94:95] op_sel_hi:[1,0,1] neg_lo:[0,0,1] neg_hi:[0,0,1]
  v_cvt_pk_bf16_f32 v129, v80, v82
  v_cvt_pk_bf16_f32 v133, v81, v83
  v_cvt_pk_bf16_f32 v137, v84, v86
  v_cvt_pk_bf16_f32 v141, v85, v87
  v_cvt_pk_bf16_f32 v145, v88, v90
  v_cvt_pk_bf16_f32 v149, v89, v91
  v_cvt_pk_bf16_f32 v153, v92, v94
  v_cvt_pk_bf16_f32 v157, v93, v95
  v_pk_fma_f32 v[80:81], v[82:83], v[220:221], v[80:81] op_sel_hi:[1,0,1] neg_lo:[0,0,1] neg_hi:[0,0,1]
  buffer_load_dwordx4 v21, s[24:27], s62 offen offset:3072 lds
  v_pk_fma_f32 v[84:85], v[86:87], v[220:221], v[84:85] op_sel_hi:[1,0,1] neg_lo:[0,0,1] neg_hi:[0,0,1]
  v_pk_fma_f32 v[88:89], v[90:91], v[224:225], v[88:89] op_sel_hi:[1,0,1] neg_lo:[0,0,1] neg_hi:[0,0,1]
  v_pk_fma_f32 v[92:93], v[94:95], v[224:225], v[92:93] op_sel_hi:[1,0,1] neg_lo:[0,0,1] neg_hi:[0,0,1]
  v_pk_fma_f32 v[82:83], v[80:81], v[220:221], v[82:83] op_sel_hi:[1,0,1] neg_lo:[0,0,1] neg_hi:[0,0,1]
  v_pk_fma_f32 v[86:87], v[84:85], v[220:221], v[86:87] op_sel_hi:[1,0,1] neg_lo:[0,0,1] neg_hi:[0,0,1]
  v_pk_fma_f32 v[90:91], v[88:89], v[224:225], v[90:91] op_sel_hi:[1,0,1] neg_lo:[0,0,1] neg_hi:[0,0,1]
  v_pk_fma_f32 v[94:95], v[92:93], v[224:225], v[94:95] op_sel_hi:[1,0,1] neg_lo:[0,0,1] neg_hi:[0,0,1]
  v_cvt_pk_bf16_f32 v130, v80, v82
  v_cvt_pk_bf16_f32 v134, v81, v83
  v_cvt_pk_bf16_f32 v138, v84, v86
  v_cvt_pk_bf16_f32 v142, v85, v87
  v_cvt_pk_bf16_f32 v146, v88, v90
  v_cvt_pk_bf16_f32 v150, v89, v91
  v_cvt_pk_bf16_f32 v154, v92, v94
  v_cvt_pk_bf16_f32 v158, v93, v95
  v_pk_fma_f32 v[80:81], v[82:83], v[220:221], v[80:81] op_sel_hi:[1,0,1] neg_lo:[0,0,1] neg_hi:[0,0,1]
  v_pk_fma_f32 v[84:85], v[86:87], v[220:221], v[84:85] op_sel_hi:[1,0,1] neg_lo:[0,0,1] neg_hi:[0,0,1]
  v_pk_fma_f32 v[88:89], v[90:91], v[224:225], v[88:89] op_sel_hi:[1,0,1] neg_lo:[0,0,1] neg_hi:[0,0,1]
  v_pk_fma_f32 v[92:93], v[94:95], v[224:225], v[92:93] op_sel_hi:[1,0,1] neg_lo:[0,0,1] neg_hi:[0,0,1]
  v_pk_fma_f32 v[82:83], v[80:81], v[220:221], v[82:83] op_sel_hi:[1,0,1] neg_lo:[0,0,1] neg_hi:[0,0,1]
  v_pk_fma_f32 v[86:87], v[84:85], v[220:221], v[86:87] op_sel_hi:[1,0,1] neg_lo:[0,0,1] neg_hi:[0,0,1]
  v_pk_fma_f32 v[90:91], v[88:89], v[224:225], v[90:91] op_sel_hi:[1,0,1] neg_lo:[0,0,1] neg_hi:[0,0,1]
  v_pk_fma_f32 v[94:95], v[92:93], v[224:225], v[94:95] op_sel_hi:[1,0,1] neg_lo:[0,0,1] neg_hi:[0,0,1]
  v_cvt_pk_bf16_f32 v131, v80, v82
  v_cvt_pk_bf16_f32 v135, v81, v83
  v_mul_f32 v86, v86, v201
  v_cvt_pk_bf16_f32 v139, v84, v86
  v_cvt_pk_bf16_f32 v143, v85, v87
  v_cvt_pk_bf16_f32 v147, v88, v90
  v_cvt_pk_bf16_f32 v151, v89, v91
  v_mul_f32 v94, v94, v201
  v_cvt_pk_bf16_f32 v155, v92, v94
  v_cvt_pk_bf16_f32 v159, v93, v95
  v_mov_b32 v4, s20
  v_mov_b32 v5, s21
  v_bfe_i32 v7, v2, 0, 1
  v_bfi_b32 v10, v7, v5, v4
  v_lshlrev_b32 v96, 16, v244
  v_and_b32 v97, s57, v244
  v_lshlrev_b32 v98, 16, v245
  v_and_b32 v99, s57, v245
  v_lshlrev_b32 v100, 16, v246
  v_and_b32 v101, s57, v246
  v_lshlrev_b32 v102, 16, v247
  v_and_b32 v103, s57, v247
  v_lshlrev_b32 v104, 16, v248
  v_and_b32 v105, s57, v248
  v_lshlrev_b32 v106, 16, v249
  v_and_b32 v107, s57, v249
  v_lshlrev_b32 v108, 16, v250
  v_and_b32 v109, s57, v250
  v_lshlrev_b32 v110, 16, v251
  v_and_b32 v111, s57, v251
  v_pk_add_f32 v[96:97], v[96:97], v[10:11] op_sel_hi:[1,0] neg_lo:[0,1] neg_hi:[0,1]
  v_pk_add_f32 v[98:99], v[98:99], v[10:11] op_sel_hi:[1,0] neg_lo:[0,1] neg_hi:[0,1]
  v_pk_add_f32 v[100:101], v[100:101], v[10:11] op_sel_hi:[1,0] neg_lo:[0,1] neg_hi:[0,1]
  v_pk_add_f32 v[102:103], v[102:103], v[10:11] op_sel_hi:[1,0] neg_lo:[0,1] neg_hi:[0,1]
  v_pk_add_f32 v[104:105], v[104:105], v[10:11] op_sel_hi:[1,0] neg_lo:[0,1] neg_hi:[0,1]
  v_pk_add_f32 v[106:107], v[106:107], v[10:11] op_sel_hi:[1,0] neg_lo:[0,1] neg_hi:[0,1]
  v_pk_add_f32 v[108:109], v[108:109], v[10:11] op_sel_hi:[1,0] neg_lo:[0,1] neg_hi:[0,1]
  v_pk_add_f32 v[110:111], v[110:111], v[10:11] op_sel_hi:[1,0] neg_lo:[0,1] neg_hi:[0,1]
  s_waitcnt vmcnt(14)
  buffer_load_dwordx4 v[56:59], v254, s[32:35], s51 offen sc1
  buffer_load_dwordx4 v[60:63], v255, s[32:35], s51 offen sc1
  s_waitcnt lgkmcnt(0)
  s_barrier
  ds_read_b64_tr_b16 a[64:65], v28 offset:0
  s_add_u32 m0, s47, 16384
  s_add_u32 s62, s62, s63
  buffer_load_dwordx4 v18, s[24:27], s62 offen offset:0 lds
  ds_read_b64_tr_b16 a[66:67], v28 offset:2048
  ds_read_b64_tr_b16 a[68:69], v28 offset:8192
  ds_read_b64_tr_b16 a[70:71], v28 offset:10240
  ds_read_b64_tr_b16 a[72:73], v29 offset:0
  ds_read_b64_tr_b16 a[74:75], v29 offset:2048
  ds_read_b64_tr_b16 a[76:77], v29 offset:8192
  ds_read_b64_tr_b16 a[78:79], v29 offset:10240
  s_mov_b64 exec, 0
  s_cmp_eq_u32 s40, 0
  s_cbranch_scc1 L_page4
  s_cmp_eq_u32 s40, 1
  s_cbranch_scc1 L_page5
  s_cmp_eq_u32 s40, 2
  s_cbranch_scc1 L_page6
L_hop456:
  s_mov_b64 exec, -1
  s_mov_b32 s60, 0x05040100
  s_mov_b32 s61, 0x07060302
  s_waitcnt lgkmcnt(0)
  s_barrier
  buffer_load_dwordx4 v19, s[24:27], s62 offen offset:1024 lds
  buffer_load_dwordx4 v20, s[24:27], s62 offen offset:2048 lds
  buffer_load_dwordx4 v21, s[24:27], s62 offen offset:3072 lds
  s_waitcnt vmcnt(4)
L_x2:
  v_max3_u32 v4, v56, v57, v58
  v_max3_u32 v5, v59, v60, v61
  v_max3_u32 v4, v4, v62, v63
  v_max_u32 v4, v4, v5
  v_cmp_eq_u32 vcc, -1, v4
  v_perm_b32 v80, v57, v56, s60
  v_perm_b32 v81, v59, v58, s60
  v_perm_b32 v82, v61, v60, s60
  v_perm_b32 v83, v63, v62, s60
  s_cbranch_vccnz L_x2_re
  s_add_u32 s12, s12, s1
  v_mfma_f32_16x16x32_bf16 v[64:67], v[80:83], v[168:171], 0
  s_lshl_b32 s13, s55, 12
  v_perm_b32 v84, v57, v56, s61
  v_perm_b32 v85, v59, v58, s61
  v_mfma_f32_16x16x32_bf16 v[72:75], v[80:83], v[184:187], 0
  s_add_u32 s13, s13, s1
  v_perm_b32 v86, v61, v60, s61
  v_perm_b32 v87, v63, v62, s61
  v_mfma_f32_16x16x32_bf16 v[236:239], v[80:83], v[128:131], 0
  s_lshl_b32 s0, s0, 14
  v_xor_b32_dpp v88, v80, v253 quad_perm:[1,0,3,2] row_mask:0xf bank_mask:0xf
  v_xor_b32_dpp v89, v81, v253 quad_perm:[1,0,3,2] row_mask:0xf bank_mask:0xf
  v_mfma_f32_16x16x32_bf16 v[68:71], v[84:87], v[176:179], 0
  s_and_b32 s1, s50, 1
  v_xor_b32_dpp v90, v82, v253 quad_perm:[1,0,3,2] row_mask:0xf bank_mask:0xf
  v_xor_b32_dpp v91, v83, v253 quad_perm:[1,0,3,2] row_mask:0xf bank_mask:0xf
  v_mfma_f32_16x16x32_bf16 v[76:79], v[84:87], v[192:195], 0
  s_add_u32 m0, s47, 32768
  s_add_u32 s62, s62, s63
  buffer_load_dwordx4 v18, s[24:27], s62 offen offset:0 lds
  s_lshl_b32 s1, s1, 12
  v_xor_b32_dpp v92, v84, v253 quad_perm:[1,0,3,2] row_mask:0xf bank_mask:0xf
  v_xor_b32_dpp v93, v85, v253 quad_perm:[1,0,3,2] row_mask:0xf bank_mask:0xf
  v_mfma_f32_16x16x32_bf16 v[64:67], v[88:91], v[172:175], v[64:67]
  s_add_u32 s0, s0, s1
  v_xor_b32_dpp v94, v86, v253 quad_perm:[1,0,3,2] row_mask:0xf bank_mask:0xf
  v_xor_b32_dpp v95, v87, v253 quad_perm:[1,0,3,2] row_mask:0xf bank_mask:0xf
  v_mfma_f32_16x16x32_bf16 v[72:75], v[88:91], v[188:191], v[72:75]
  s_lshr_b32 s1, s47, 2
  v_mfma_f32_16x16x32_bf16 v[68:71], v[92:95], v[180:183], v[68:71]
  buffer_load_dwordx4 v19, s[24:27], s62 offen offset:1024 lds
  s_add_u32 s1, s1, 5242880
  v_mfma_f32_16x16x32_bf16 v[76:79], v[92:95], v[196:199], v[76:79]
  s_add_u32 s0, s0, s1
  v_cvt_pk_bf16_f32 v212, v64, v65
  v_cvt_pk_bf16_f32 v213, v66, v67
  v_mfma_f32_16x16x32_bf16 v[240:243], v[84:87], v[136:139], 0
  s_lshl_b32 s68, s50, 18
  v_cvt_pk_bf16_f32 v216, v72, v73
  buffer_load_dwordx4 v20, s[24:27], s62 offen offset:2048 lds
  v_cvt_pk_bf16_f32 v217, v74, v75
  v_mfma_f32_16x16x32_bf16 v[236:239], v[88:91], v[132:135], v[236:239]
  s_add_u32 s68, s68, s0
  v_cvt_pk_bf16_f32 v214, v68, v69
  v_cvt_pk_bf16_f32 v215, v70, v71
  v_mfma_f32_16x16x32_bf16 v[240:243], v[92:95], v[140:143], v[240:243]
  s_lshl_b32 s69, s55, 18
  v_cvt_pk_bf16_f32 v218, v76, v77
  buffer_load_dwordx4 v21, s[24:27], s62 offen offset:3072 lds
  v_cvt_pk_bf16_f32 v219, v78, v79
  v_mfma_f32_16x16x32_bf16 v[244:247], v[80:83], v[144:147], 0
  s_add_u32 s69, s69, s0
  ds_write_b128 v210, v[212:215] offset:0
  v_mfma_f32_16x16x32_bf16 v[248:251], v[84:87], v[152:155], 0
  s_and_b32 s0, s42, 3
  ds_write_b128 v210, v[216:219] offset:1024
  v_cvt_pk_bf16_f32 v220, v236, v237
  s_add_u32 m0, s47, 49152
  s_add_u32 s62, s62, s63
  buffer_load_dwordx4 v18, s[24:27], s62 offen offset:0 lds
  v_mfma_f32_16x16x32_bf16 v[244:247], v[88:91], v[148:151], v[244:247]
  s_lshl2_add_u32 s0, s41, s0
  v_cvt_pk_bf16_f32 v221, v238, v239
  v_cvt_pk_bf16_f32 v222, v240, v241
  v_mfma_f32_16x16x32_bf16 v[248:251], v[92:95], v[156:159], v[248:251]
  s_lshl_b32 s50, s0, 12
  v_cvt_pk_bf16_f32 v223, v242, v243
  ds_write_b128 v210, v[220:223] offset:2048
  buffer_load_dwordx4 v19, s[24:27], s62 offen offset:1024 lds
  v_cvt_pk_bf16_f32 v224, v244, v245
  v_cvt_pk_bf16_f32 v225, v246, v247
  s_add_u32 s14, s14, s50
  s_and_b32 s50, s0, 1
  v_cvt_pk_bf16_f32 v226, v248, v249
  v_cvt_pk_bf16_f32 v227, v250, v251
  ds_write_b128 v210, v[224:227] offset:3072
  s_waitcnt vmcnt(6)
  s_waitcnt lgkmcnt(0)
  s_barrier
  ds_read_b128 v[168:171], v211 offset:0
  buffer_load_dwordx4 v20, s[24:27], s62 offen offset:2048 lds
  ds_read_b128 v[172:175], v211 offset:1024
  ds_read_b128 v[184:187], v211 offset:4096
  ds_read_b128 v[188:191], v211 offset:5120
  ds_read_b128 v[128:131], v211 offset:8192
  ds_read_b128 v[132:135], v211 offset:9216
  s_waitcnt lgkmcnt(5)
  v_mfma_f32_16x16x32_bf16 v[96:99], v[168:171], v[112:115], v[96:99]
  s_waitcnt lgkmcnt(4)
  ds_read_b128 v[144:147], v211 offset:12288
  buffer_load_dwordx4 v21, s[24:27], s62 offen offset:3072 lds
  v_mfma_f32_16x16x32_bf16 v[100:103], v[172:175], v[112:115], v[100:103]
  s_waitcnt lgkmcnt(4)
  ds_read_b128 v[148:151], v211 offset:13312
  v_mfma_f32_16x16x32_bf16 v[96:99], v[184:187], v[116:119], v[96:99]
  s_waitcnt lgkmcnt(4)
  ds_read_b128 v[176:179], v211 offset:2048
  v_mfma_f32_16x16x32_bf16 v[100:103], v[188:191], v[116:119], v[100:103]
  s_add_u32 m0, s47, 65536
  s_add_u32 s62, s62, s63
  buffer_load_dwordx4 v18, s[24:27], s62 offen offset:0 lds
  s_waitcnt lgkmcnt(4)
  ds_read_b128 v[180:183], v211 offset:3072
  v_mfma_f32_16x16x32_bf16 v[96:99], v[128:131], v[120:123], v[96:99]
  s_waitcnt lgkmcnt(4)
  ds_read_b128 v[192:195], v211 offset:6144
  v_mfma_f32_16x16x32_bf16 v[100:103], v[132:135], v[120:123], v[100:103]
  s_waitcnt lgkmcnt(4)
  ds_read_b128 v[196:199], v211 offset:7168
  buffer_load_dwordx4 v19, s[24:27], s62 offen offset:1024 lds
  v_mfma_f32_16x16x32_bf16 v[96:99], v[144:147], v[124:127], v[96:99]
  s_waitcnt lgkmcnt(4)
  ds_read_b128 v[136:139], v211 offset:10240
  v_mfma_f32_16x16x32_bf16 v[100:103], v[148:151], v[124:127], v[100:103]
  s_waitcnt lgkmcnt(4)
  ds_read_b128 v[140:143], v211 offset:11264
  v_mfma_f32_16x16x32_bf16 v[104:107], v[176:179], v[112:115], v[104:107]
  buffer_load_dwordx4 v20, s[24:27], s62 offen offset:2048 lds
  s_waitcnt lgkmcnt(4)
  ds_read_b128 v[152:155], v211 offset:14336
  v_mfma_f32_16x16x32_bf16 v[108:111], v[180:183], v[112:115], v[108:111]
  s_waitcnt lgkmcnt(4)
  ds_read_b128 v[156:159], v211 offset:15360
  v_mfma_f32_16x16x32_bf16 v[104:107], v[192:195], v[116:119], v[104:107]
  s_waitcnt lgkmcnt(4)
  v_mfma_f32_16x16x32_bf16 v[108:111], v[196:199], v[116:119], v[108:111]
  buffer_load_dwordx4 v21, s[24:27], s62 offen offset:3072 lds
  s_waitcnt lgkmcnt(3)
  v_mul_f32 v212, v96, v96
  v_mul_f32 v213, v97, v97
  v_mfma_f32_16x16x32_bf16 v[104:107], v[136:139], v[120:123], v[104:107]
  s_waitcnt lgkmcnt(2)
  v_fmac_f32 v212, v98, v98
  v_fmac_f32 v213, v99, v99
  v_mfma_f32_16x16x32_bf16 v[108:111], v[140:143], v[120:123], v[108:111]
  s_waitcnt lgkmcnt(1)
  v_fmac_f32 v212, v100, v100
  v_fmac_f32 v213, v101, v101
  v_mfma_f32_16x16x32_bf16 v[104:107], v[152:155], v[124:127], v[104:107]
  s_waitcnt lgkmcnt(0)
  v_fmac_f32 v212, v102, v102
  v_fmac_f32 v213, v103, v103
  v_mfma_f32_16x16x32_bf16 v[108:111], v[156:159], v[124:127], v[108:111]
  s_mov_b32 s58, 0x3c11afa3
  v_mov_b32 v216, 0x383ef424
  s_xor_b32 s55, s50, 1
  s_lshl_b32 s0, s0, 18
  v_pk_mul_f32 v[214:215], v[104:105], v[104:105]
  v_pk_fma_f32 v[212:213], v[106:107], v[106:107], v[212:213]
  s_add_u32 s0, s0, s1
  s_lshl_b32 s16, s50, 12
  v_pk_fma_f32 v[214:215], v[108:109], v[108:109], v[214:215]
  v_pk_fma_f32 v[212:213], v[110:111], v[110:111], v[212:213]
  v_pk_add_f32 v[212:213], v[212:213], v[214:215]
  v_add_f32 v214, v212, v213
  v_add_f32 v212, v212, v213
  s_add_u32 s16, s16, s0
  s_lshl_b32 s17, s55, 12
  v_permlane32_swap_b32 v212, v214
  v_add_f32 v213, v212, v214
  v_add_f32 v212, v212, v214
  s_add_u32 s17, s17, s0
  s_lshr_b32 s0, s42, 2
  v_permlane16_swap_b32 v212, v213
  v_add_f32 v212, v212, v213
  s_xor_b32 s0, s0, 4
  s_lshl_b32 s3, s0, 7
  v_add_f32_dpp v212, v212, v212 quad_perm:[2,3,0,1] row_mask:0xf bank_mask:0xf
  s_lshl_b32 s15, s0, 8
  s_lshl3_add_u32 s0, s47, s3
  v_add_f32_dpp v212, v212, v212 row_ror:4 row_mask:0xf bank_mask:0xf
  s_lshl_b32 s18, s50, 17
  s_add_u32 s18, s18, s0
  v_add_f32_dpp v212, v212, v212 row_ror:8 row_mask:0xf bank_mask:0xf
  v_fma_f32 v214, v212, s58, v216
  v_rsq_f32 v212, v214
  s_lshl_b32 s19, s55, 17
  v_pk_mul_f32 v[96:97], v[96:97], v[212:213] op_sel_hi:[1,0]
  v_pk_mul_f32 v[98:99], v[98:99], v[212:213] op_sel_hi:[1,0]
  v_pk_mul_f32 v[100:101], v[100:101], v[212:213] op_sel_hi:[1,0]
  v_pk_mul_f32 v[102:103], v[102:103], v[212:213] op_sel_hi:[1,0]
  v_cvt_pk_bf16_f32 v56, v96, v97
  v_cvt_pk_bf16_f32 v57, v98, v99
  v_cvt_pk_bf16_f32 v58, v100, v101
  v_cvt_pk_bf16_f32 v59, v102, v103
  v_min_u32 v56, -2, v56
  v_min_u32 v57, -2, v57
  v_min_u32 v58, -2, v58
  v_min_u32 v59, -2, v59
  v_pk_mul_f32 v[104:105], v[104:105], v[212:213] op_sel_hi:[1,0]
  v_pk_mul_f32 v[106:107], v[106:107], v[212:213] op_sel_hi:[1,0]
  v_pk_mul_f32 v[108:109], v[108:109], v[212:213] op_sel_hi:[1,0]
  v_pk_mul_f32 v[110:111], v[110:111], v[212:213] op_sel_hi:[1,0]
  v_cvt_pk_bf16_f32 v60, v104, v105
  v_cvt_pk_bf16_f32 v61, v106, v107
  v_cvt_pk_bf16_f32 v62, v108, v109
  v_cvt_pk_bf16_f32 v63, v110, v111
  v_min_u32 v60, -2, v60
  v_min_u32 v61, -2, v61
  v_min_u32 v62, -2, v62
  v_min_u32 v63, -2, v63
  s_cmp_eq_u32 s44, 0
  s_cbranch_scc1 L_slow1
  buffer_store_dwordx4 v[56:59], v252, s[32:35], s53 offen offset:0
  buffer_store_dwordx4 v[60:63], v252, s[32:35], s53 offen offset:128
L_back1:
  v_mul_f32 v11, v214, v212
  v_lshrrev_b32 v4, 3, v1
  v_and_b32 v5, 0x70, v17
  v_lshl_add_u32 v242, v4, 11, v5
  ds_read_b64_tr_b16 a[80:81], v28 offset:16384
  ds_read_b64_tr_b16 a[82:83], v28 offset:18432
  ds_read_b64_tr_b16 a[84:85], v28 offset:24576
  ds_read_b64_tr_b16 a[86:87], v28 offset:26624
  ds_read_b64_tr_b16 a[88:89], v29 offset:16384
  ds_read_b64_tr_b16 a[90:91], v29 offset:18432
  ds_read_b64_tr_b16 a[92:93], v29 offset:24576
  ds_read_b64_tr_b16 a[94:95], v29 offset:26624
  ds_read_b64_tr_b16 a[96:97], v28 offset:32768
  ds_read_b64_tr_b16 a[98:99], v28 offset:34816
  ds_read_b64_tr_b16 a[100:101], v28 offset:40960
  ds_read_b64_tr_b16 a[102:103], v28 offset:43008
  ds_read_b64_tr_b16 a[104:105], v29 offset:32768
  ds_read_b64_tr_b16 a[106:107], v29 offset:34816
  ds_read_b64_tr_b16 a[108:109], v29 offset:40960
  ds_read_b64_tr_b16 a[110:111], v29 offset:43008
  ds_read_b64_tr_b16 a[112:113], v28 offset:49152
  ds_read_b64_tr_b16 a[114:115], v28 offset:51200
  ds_read_b64_tr_b16 a[116:117], v28 offset:57344
  ds_read_b64_tr_b16 a[118:119], v28 offset:59392
  ds_read_b64_tr_b16 a[120:121], v29 offset:49152
  ds_read_b64_tr_b16 a[122:123], v29 offset:51200
  ds_read_b64_tr_b16 a[124:125], v29 offset:57344
  ds_read_b64_tr_b16 a[126:127], v29 offset:59392
  ds_read_b64_tr_b16 a[128:129], v26 offset:0
  ds_read_b64_tr_b16 a[130:131], v26 offset:2048
  ds_read_b64_tr_b16 a[132:133], v26 offset:8192
  ds_read_b64_tr_b16 a[134:135], v26 offset:10240
  ds_read_b64_tr_b16 a[136:137], v27 offset:0
  ds_read_b64_tr_b16 a[138:139], v27 offset:2048
  ds_read_b64_tr_b16 a[140:141], v27 offset:8192
  ds_read_b64_tr_b16 a[142:143], v27 offset:10240
  ds_read_b64_tr_b16 a[144:145], v26 offset:16384
  ds_read_b64_tr_b16 a[146:147], v26 offset:18432
  ds_read_b64_tr_b16 a[148:149], v26 offset:24576
  ds_read_b64_tr_b16 a[150:151], v26 offset:26624
  ds_read_b64_tr_b16 a[152:153], v27 offset:16384
  ds_read_b64_tr_b16 a[154:155], v27 offset:18432
  ds_read_b64_tr_b16 a[156:157], v27 offset:24576
  ds_read_b64_tr_b16 a[158:159], v27 offset:26624
  s_add_u32 s19, s19, s0
  s_and_b32 s0, s42, 3
  s_lshl2_add_u32 s0, s41, s0
  s_lshl_b32 s1, s0, 13
  s_add_u32 s3, s3, s1
  s_lshl4_add_u32 s0, s0, s40
  s_lshl_b32 s1, s0, 12
  s_add_u32 s15, s15, s1
  s_lshl_b32 s1, s0, 6
  s_add_u32 s11, s1, 4257792
  s_lshl_b32 s4, s41, 14
  s_cmp_eq_u32 s4, 114688
  s_cselect_b32 s4, 0, s4
  s_add_u32 s5, s4, 0x4000
  s_cmp_eq_u32 s5, 114688
  s_cselect_b32 s5, 0, s5
  s_add_u32 s6, s5, 0x4000
  s_cmp_eq_u32 s6, 114688
  s_cselect_b32 s6, 0, s6
  s_add_u32 s7, s6, 0x4000
  s_cmp_eq_u32 s7, 114688
  s_cselect_b32 s7, 0, s7
  s_add_u32 s8, s7, 0x4000
  s_cmp_eq_u32 s8, 114688
  s_cselect_b32 s8, 0, s8
  s_add_u32 s9, s8, 0x4000
  s_cmp_eq_u32 s9, 114688
  s_cselect_b32 s9, 0, s9
  s_add_u32 s10, s9, 0x4000
  s_cmp_eq_u32 s10, 114688
  s_cselect_b32 s10, 0, s10
  v_lshrrev_b32 v4, 1, v2
  v_and_b32 v5, 6, v4
  s_movk_i32 s58, 0x78
  v_bfe_u32 v5, s58, v5, 2
  v_xor_b32 v5, v5, v3
  v_lshlrev_b32 v4, 7, v4
  v_lshl_add_u32 v4, v5, 5, v4
  v_and_or_b32 v243, v17, 16, v4
  v_lshlrev_b32 v30, 25, v1
  v_add_u32 v31, 131072, v243
  s_add_u32 s58, s47, 131072
  v_add_u32 v244, s58, v17
  s_mov_b32 s59, 0xc09d30fc
  s_add_u32 s61, s66, 16384
  s_waitcnt vmcnt(0)
  buffer_load_dwordx4 v[208:211], v242, s[32:35], s66 offen offset:0 sc1
  buffer_load_dwordx4 v[212:215], v242, s[32:35], s66 offen offset:128 sc1
  buffer_load_dwordx4 v[216:219], v242, s[32:35], s66 offen offset:256 sc1
  buffer_load_dwordx4 v[220:223], v242, s[32:35], s66 offen offset:384 sc1
  s_mov_b64 exec, 3
  s_cmp_eq_u32 s44, 0
  s_cbranch_scc1 L_slow2
  buffer_store_dwordx4 v[8:11], v17, s[32:35], s52 offen
L_back2:
  s_mov_b64 exec, -1
  s_cmp_ge_u32 s42, 28
  s_cbranch_scc1 L_touch
  s_waitcnt vmcnt(1)
L_h0:
  v_max3_u32 v248, v208, v209, v210
  v_max3_u32 v249, v213, v214, v215
  v_max3_u32 v250, v218, v219, v220
  v_max3_u32 v248, v248, v211, v212
  v_max3_u32 v249, v249, v216, v217
  v_max3_u32 v250, v250, v221, v222
  v_max3_u32 v248, v248, v249, v223
  v_max_u32 v248, v248, v250
  v_cmp_eq_u32 vcc, -1, v248
  ds_write_b128 v244, v[208:211] offset:0
  ds_write_b128 v244, v[212:215] offset:1024
  ds_write_b128 v244, v[216:219] offset:2048
  ds_write_b128 v244, v[220:223] offset:3072
  s_cbranch_vccnz L_h0_re
  buffer_load_dwordx4 v[224:227], v242, s[32:35], s61 offen offset:0 sc1
  buffer_load_dwordx4 v[228:231], v242, s[32:35], s61 offen offset:128 sc1
  buffer_load_dwordx4 v[232:235], v242, s[32:35], s61 offen offset:256 sc1
  buffer_load_dwordx4 v[236:239], v242, s[32:35], s61 offen offset:384 sc1
  s_waitcnt lgkmcnt(0)
  s_barrier
  ds_read_b128 v[176:179], v31 offset:0
  ds_read_b128 v[180:183], v31 offset:1024
  ds_read_b128 v[184:187], v31 offset:2048
  ds_read_b128 v[188:191], v31 offset:3072
  s_add_u32 m0, s47, 81920
  s_add_u32 s62, s62, s63
  buffer_load_dwordx4 v18, s[24:27], s62 offen offset:0 lds
  buffer_load_dwordx4 v19, s[24:27], s62 offen offset:1024 lds
  buffer_load_dwordx4 v20, s[24:27], s62 offen offset:2048 lds
  buffer_load_dwordx4 v21, s[24:27], s62 offen offset:3072 lds
  s_waitcnt lgkmcnt(3)
  v_mfma_f32_16x16x32_bf16 v[144:147], a[0:3], v[176:179], 0
  s_waitcnt lgkmcnt(2)
  ds_read_b128 v[192:195], v31 offset:4096
  ds_read_b128 v[196:199], v31 offset:5120
  v_mfma_f32_16x16x32_bf16 v[144:147], a[16:19], v[180:183], v[144:147]
  s_waitcnt lgkmcnt(3)
  s_add_u32 m0, s47, 98304
  s_add_u32 s62, s62, s63
  buffer_load_dwordx4 v18, s[24:27], s62 offen offset:0 lds
  ds_read_b64_tr_b16 a[160:161], v26 offset:32768
  v_mfma_f32_16x16x32_bf16 v[144:147], a[32:35], v[184:187], v[144:147]
  s_waitcnt lgkmcnt(3)
  ds_read_b128 v[200:203], v31 offset:6144
  ds_read_b128 v[204:207], v31 offset:7168
  v_mfma_f32_16x16x32_bf16 v[144:147], a[48:51], v[188:191], v[144:147]
  ds_read_b64_tr_b16 a[162:163], v26 offset:34816
  v_mfma_f32_16x16x32_bf16 v[148:151], a[4:7], v[176:179], 0
  s_waitcnt vmcnt(5)
  v_max3_u32 v252, v224, v225, v226
  v_max3_u32 v253, v229, v230, v231
  v_mfma_f32_16x16x32_bf16 v[148:151], a[20:23], v[180:183], v[148:151]
  v_max3_u32 v254, v234, v235, v236
  v_max3_u32 v252, v252, v227, v228
  v_mfma_f32_16x16x32_bf16 v[148:151], a[36:39], v[184:187], v[148:151]
  v_max3_u32 v253, v253, v232, v233
  v_max3_u32 v254, v254, v237, v238
  v_mfma_f32_16x16x32_bf16 v[148:151], a[52:55], v[188:191], v[148:151]
  v_max3_u32 v252, v252, v253, v239
  v_max_u32 v252, v252, v254
  v_mfma_f32_16x16x32_bf16 v[152:155], a[8:11], v[176:179], 0
  buffer_load_dwordx4 v19, s[24:27], s62 offen offset:1024 lds
  v_cmp_eq_u32 vcc, -1, v252
  v_mfma_f32_16x16x32_bf16 v[152:155], a[24:27], v[180:183], v[152:155]
  s_cbranch_vccnz L_h1_re
L_h1:
  ds_read_b64_tr_b16 a[164:165], v26 offset:40960
  v_mfma_f32_16x16x32_bf16 v[152:155], a[40:43], v[184:187], v[152:155]
  ds_write_b128 v244, v[224:227] offset:16384
  ds_read_b64_tr_b16 a[166:167], v26 offset:43008
  v_mfma_f32_16x16x32_bf16 v[152:155], a[56:59], v[188:191], v[152:155]
  ds_read_b64_tr_b16 a[168:169], v27 offset:32768
  v_mfma_f32_16x16x32_bf16 v[156:159], a[12:15], v[176:179], 0
  buffer_load_dwordx2 v[12:13], v17, s[32:35], s22 offen sc1
  ds_read_b64_tr_b16 a[170:171], v27 offset:34816
  v_mfma_f32_16x16x32_bf16 v[156:159], a[28:31], v[180:183], v[156:159]
  ds_read_b64_tr_b16 a[172:173], v27 offset:40960
  v_mfma_f32_16x16x32_bf16 v[156:159], a[44:47], v[184:187], v[156:159]
  ds_write_b128 v244, v[228:231] offset:17408
  ds_read_b64_tr_b16 a[174:175], v27 offset:43008
  v_mfma_f32_16x16x32_bf16 v[156:159], a[60:63], v[188:191], v[156:159]
  s_waitcnt lgkmcnt(9)
  buffer_load_dwordx4 v20, s[24:27], s62 offen offset:2048 lds
  ds_read_b64_tr_b16 a[176:177], v26 offset:49152
  v_mfma_f32_16x16x32_bf16 v[144:147], a[64:67], v[192:195], v[144:147]
  ds_read_b128 v[176:179], v31 offset:8192
  ds_read_b128 v[180:183], v31 offset:9216
  v_mfma_f32_16x16x32_bf16 v[144:147], a[80:83], v[196:199], v[144:147]
  ds_read_b64_tr_b16 a[178:179], v26 offset:51200
  v_mfma_f32_16x16x32_bf16 v[144:147], a[96:99], v[200:203], v[144:147]
  ds_read_b128 v[184:187], v31 offset:10240
  ds_read_b128 v[188:191], v31 offset:11264
  v_mfma_f32_16x16x32_bf16 v[144:147], a[112:115], v[204:207], v[144:147]
  ds_write_b128 v244, v[232:235] offset:18432
  buffer_load_dwordx4 v21, s[24:27], s62 offen offset:3072 lds
  v_mfma_f32_16x16x32_bf16 v[148:151], a[68:71], v[192:195], v[148:151]
  ds_read_b64_tr_b16 a[180:181], v26 offset:57344
  v_mfma_f32_16x16x32_bf16 v[148:151], a[84:87], v[196:199], v[148:151]
  ds_read_b64_tr_b16 a[182:183], v26 offset:59392
  v_mfma_f32_16x16x32_bf16 v[148:151], a[100:103], v[200:203], v[148:151]
  s_add_u32 m0, s47, 114688
  s_add_u32 s62, s62, s63
  buffer_load_dwordx4 v18, s[24:27], s62 offen offset:0 lds
  ds_read_b64_tr_b16 a[184:185], v27 offset:49152
  v_mfma_f32_16x16x32_bf16 v[148:151], a[116:119], v[204:207], v[148:151]
  ds_write_b128 v244, v[236:239] offset:19456
  ds_read_b64_tr_b16 a[186:187], v27 offset:51200
  v_mfma_f32_16x16x32_bf16 v[152:155], a[72:75], v[192:195], v[152:155]
  ds_read_b64_tr_b16 a[188:189], v27 offset:57344
  v_mfma_f32_16x16x32_bf16 v[152:155], a[88:91], v[196:199], v[152:155]
  buffer_load_dwordx4 v19, s[24:27], s62 offen offset:1024 lds
  ds_read_b64_tr_b16 a[190:191], v27 offset:59392
  v_mfma_f32_16x16x32_bf16 v[152:155], a[104:107], v[200:203], v[152:155]
  ds_read_b64_tr_b16 a[192:193], v28 offset:0
  v_mfma_f32_16x16x32_bf16 v[152:155], a[120:123], v[204:207], v[152:155]
  ds_read_b64_tr_b16 a[194:195], v28 offset:2048
  v_mfma_f32_16x16x32_bf16 v[156:159], a[76:79], v[192:195], v[156:159]
  buffer_load_dwordx4 v20, s[24:27], s62 offen offset:2048 lds
  ds_read_b64_tr_b16 a[196:197], v28 offset:8192
  v_mfma_f32_16x16x32_bf16 v[156:159], a[92:95], v[196:199], v[156:159]
L_page3:
  s_cbranch_execz L_hop123
  ds_read_b64_tr_b16 a[198:199], v28 offset:10240
  v_mfma_f32_16x16x32_bf16 v[156:159], a[108:111], v[200:203], v[156:159]
  ds_read_b64_tr_b16 a[200:201], v29 offset:0
  v_mfma_f32_16x16x32_bf16 v[156:159], a[124:127], v[204:207], v[156:159]
  s_waitcnt lgkmcnt(13)
  s_waitcnt lgkmcnt(8)
  s_waitcnt lgkmcnt(5)
  s_barrier
  buffer_load_dwordx4 v21, s[24:27], s62 offen offset:3072 lds
  v_mfma_f32_16x16x32_bf16 v[144:147], a[128:131], v[176:179], v[144:147]
  ds_read_b128 v[192:195], v31 offset:16384
  ds_read_b128 v[196:199], v31 offset:17408
  v_mfma_f32_16x16x32_bf16 v[144:147], a[144:147], v[180:183], v[144:147]
  v_lshrrev_b32 v4, 3, v1
  v_and_b32 v5, 6, v4
  v_mfma_f32_16x16x32_bf16 v[144:147], a[160:163], v[184:187], v[144:147]
  ds_read_b128 v[200:203], v31 offset:18432
  ds_read_b128 v[204:207], v31 offset:19456
  v_mfma_f32_16x16x32_bf16 v[144:147], a[176:179], v[188:191], v[144:147]
  v_and_b32 v7, 7, v1
  v_xor_b32 v5, v5, v7
  v_mfma_f32_16x16x32_bf16 v[148:151], a[132:135], v[176:179], v[148:151]
  v_lshlrev_b32 v5, 4, v5
  v_lshl_add_u32 v18, v4, 10, v5
  v_mfma_f32_16x16x32_bf16 v[148:151], a[148:151], v[180:183], v[148:151]
  v_add_u32 v19, 7168, v18
  v_add_u32 v20, 14336, v18
  v_mfma_f32_16x16x32_bf16 v[148:151], a[164:167], v[184:187], v[148:151]
  ds_read_b64_tr_b16 a[202:203], v29 offset:2048
  v_add_u32 v21, 21504, v18
  v_mfma_f32_16x16x32_bf16 v[148:151], a[180:183], v[188:191], v[148:151]
  s_add_u32 m0, s47, 16384
  ds_read_b64_tr_b16 a[204:205], v29 offset:8192
  v_mfma_f32_16x16x32_bf16 v[152:155], a[136:139], v[176:179], v[152:155]
  s_lshl4_add_u32 s61, s4, s18
  ds_read_b64_tr_b16 a[206:207], v29 offset:10240
  buffer_load_dwordx4 v18, s[28:31], s61 offen offset:0 lds
  v_mfma_f32_16x16x32_bf16 v[152:155], a[152:155], v[180:183], v[152:155]
  v_mfma_f32_16x16x32_bf16 v[152:155], a[168:171], v[184:187], v[152:155]
  v_mfma_f32_16x16x32_bf16 v[152:155], a[184:187], v[188:191], v[152:155]
  buffer_load_dwordx4 v19, s[28:31], s61 offen offset:1024 lds
  v_mfma_f32_16x16x32_bf16 v[156:159], a[140:143], v[176:179], v[156:159]
  v_mfma_f32_16x16x32_bf16 v[156:159], a[156:159], v[180:183], v[156:159]
  v_mfma_f32_16x16x32_bf16 v[156:159], a[172:175], v[184:187], v[156:159]
  buffer_load_dwordx4 v20, s[28:31], s61 offen offset:2048 lds
  v_mfma_f32_16x16x32_bf16 v[156:159], a[188:191], v[188:191], v[156:159]
  s_waitcnt lgkmcnt(3)
  v_mfma_f32_16x16x32_bf16 v[160:163], a[0:3], v[192:195], 0
  ds_read_b128 v[176:179], v31 offset:20480
  ds_read_b128 v[180:183], v31 offset:21504
  v_mfma_f32_16x16x32_bf16 v[160:163], a[16:19], v[196:199], v[160:163]
  buffer_load_dwordx4 v21, s[28:31], s61 offen offset:3072 lds
  v_mfma_f32_16x16x32_bf16 v[160:163], a[32:35], v[200:203], v[160:163]
  ds_read_b128 v[184:187], v31 offset:22528
  ds_read_b128 v[188:191], v31 offset:23552
  v_mfma_f32_16x16x32_bf16 v[160:163], a[48:51], v[204:207], v[160:163]
  v_mfma_f32_16x16x32_bf16 v[164:167], a[4:7], v[192:195], 0
  s_waitcnt vmcnt(10)
  v_cmp_ne_u64 vcc, s[48:49], v[12:13]
  v_mfma_f32_16x16x32_bf16 v[164:167], a[20:23], v[196:199], v[164:167]
  s_cbranch_vccnz L_f3_re
L_f3:
  v_mfma_f32_16x16x32_bf16 v[164:167], a[36:39], v[200:203], v[164:167]
  s_add_u32 m0, s47, 0
  v_mfma_f32_16x16x32_bf16 v[164:167], a[52:55], v[204:207], v[164:167]
  s_add_u32 s61, s66, 32768
  buffer_load_dwordx4 v242, s[32:35], s61 offen offset:0 sc1 lds
  v_mfma_f32_16x16x32_bf16 v[168:171], a[8:11], v[192:195], 0
  s_add_u32 m0, m0, 896
  v_mfma_f32_16x16x32_bf16 v[168:171], a[24:27], v[196:199], v[168:171]
  v_mfma_f32_16x16x32_bf16 v[168:171], a[40:43], v[200:203], v[168:171]
  buffer_load_dwordx4 v242, s[32:35], s61 offen offset:128 sc1 lds
  v_mfma_f32_16x16x32_bf16 v[168:171], a[56:59], v[204:207], v[168:171]
  s_add_u32 m0, m0, 896
  v_mfma_f32_16x16x32_bf16 v[172:175], a[12:15], v[192:195], 0
  v_mfma_f32_16x16x32_bf16 v[172:175], a[28:31], v[196:199], v[172:175]
  buffer_load_dwordx4 v242, s[32:35], s61 offen offset:256 sc1 lds
  v_mfma_f32_16x16x32_bf16 v[172:175], a[44:47], v[200:203], v[172:175]
  s_waitcnt vmcnt(7)
  s_waitcnt lgkmcnt(4)
  s_barrier
  s_add_u32 m0, m0, 896
  v_mfma_f32_16x16x32_bf16 v[172:175], a[60:63], v[204:207], v[172:175]
  s_waitcnt lgkmcnt(0)
  ds_read_b64_tr_b16 a[208:209], v28 offset:16384
  ds_read_b64_tr_b16 a[210:211], v28 offset:18432
  v_mfma_f32_16x16x32_bf16 v[160:163], a[64:67], v[176:179], v[160:163]
  ds_read_b128 v[192:195], v31 offset:12288
  ds_read_b128 v[196:199], v31 offset:13312
  v_mfma_f32_16x16x32_bf16 v[160:163], a[80:83], v[180:183], v[160:163]
  ds_read_b64_tr_b16 a[212:213], v28 offset:24576
  ds_read_b64_tr_b16 a[214:215], v28 offset:26624
  v_mfma_f32_16x16x32_bf16 v[160:163], a[96:99], v[184:187], v[160:163]
  ds_read_b128 v[200:203], v31 offset:14336
  ds_read_b128 v[204:207], v31 offset:15360
  v_mfma_f32_16x16x32_bf16 v[160:163], a[112:115], v[188:191], v[160:163]
  ds_read_b64_tr_b16 a[216:217], v29 offset:16384
  ds_read_b64_tr_b16 a[218:219], v29 offset:18432
  v_mfma_f32_16x16x32_bf16 v[164:167], a[68:71], v[176:179], v[164:167]
  ds_read_b64_tr_b16 a[220:221], v29 offset:24576
  ds_read_b64_tr_b16 a[222:223], v29 offset:26624
  v_mfma_f32_16x16x32_bf16 v[164:167], a[84:87], v[180:183], v[164:167]
  ds_read_b64_tr_b16 a[224:225], v28 offset:32768
  ds_read_b64_tr_b16 a[226:227], v28 offset:34816
  v_mfma_f32_16x16x32_bf16 v[164:167], a[100:103], v[184:187], v[164:167]
  buffer_load_dwordx2 v[14:15], v17, s[32:35], s23 offen sc1
  ds_read_b64_tr_b16 a[228:229], v28 offset:40960
  v_mfma_f32_16x16x32_bf16 v[164:167], a[116:119], v[188:191], v[164:167]
  ds_read_b64_tr_b16 a[230:231], v28 offset:43008
  ds_read_b64_tr_b16 a[232:233], v29 offset:32768
  v_mfma_f32_16x16x32_bf16 v[168:171], a[72:75], v[176:179], v[168:171]
  ds_read_b64_tr_b16 a[234:235], v29 offset:34816
  ds_read_b64_tr_b16 a[236:237], v29 offset:40960
  v_mfma_f32_16x16x32_bf16 v[168:171], a[88:91], v[180:183], v[168:171]
  ds_read_b64_tr_b16 a[238:239], v29 offset:43008
  ds_read_b64_tr_b16 a[240:241], v28 offset:49152
  v_mfma_f32_16x16x32_bf16 v[168:171], a[104:107], v[184:187], v[168:171]
  ds_read_b64_tr_b16 a[242:243], v28 offset:51200
  ds_read_b64_tr_b16 a[244:245], v28 offset:57344
  v_mfma_f32_16x16x32_bf16 v[168:171], a[120:123], v[188:191], v[168:171]
  ds_read_b64_tr_b16 a[246:247], v28 offset:59392
  ds_read_b64_tr_b16 a[248:249], v29 offset:49152
  v_mfma_f32_16x16x32_bf16 v[172:175], a[76:79], v[176:179], v[172:175]
  ds_read_b64_tr_b16 a[250:251], v29 offset:51200
  ds_read_b64_tr_b16 a[252:253], v29 offset:57344
  v_mfma_f32_16x16x32_bf16 v[172:175], a[92:95], v[180:183], v[172:175]
  ds_read_b64_tr_b16 a[254:255], v29 offset:59392
  buffer_load_dwordx4 v242, s[32:35], s61 offen offset:384 sc1 lds
  v_mfma_f32_16x16x32_bf16 v[172:175], a[108:111], v[184:187], v[172:175]
  s_add_u32 m0, s47, 49152
  v_mfma_f32_16x16x32_bf16 v[172:175], a[124:127], v[188:191], v[172:175]
  s_waitcnt lgkmcnt(15)
  s_lshl4_add_u32 s61, s4, s19
  v_mfma_f32_16x16x32_bf16 v[144:147], a[192:195], v[192:195], v[144:147]
  ds_read_b128 v[176:179], v31 offset:24576
  ds_read_b128 v[180:183], v31 offset:25600
  v_mfma_f32_16x16x32_bf16 v[144:147], a[208:211], v[196:199], v[144:147]
  s_waitcnt lgkmcnt(15)
  buffer_load_dwordx4 v18, s[28:31], s61 offen offset:0 lds
  v_mfma_f32_16x16x32_bf16 v[144:147], a[224:227], v[200:203], v[144:147]
  s_waitcnt lgkmcnt(8)
  ds_read_b128 v[184:187], v31 offset:26624
  ds_read_b128 v[188:191], v31 offset:27648
  v_mfma_f32_16x16x32_bf16 v[144:147], a[240:243], v[204:207], v[144:147]
  v_mfma_f32_16x16x32_bf16 v[148:151], a[196:199], v[192:195], v[148:151]
  buffer_load_dwordx4 v19, s[28:31], s61 offen offset:1024 lds
  v_mfma_f32_16x16x32_bf16 v[148:151], a[212:215], v[196:199], v[148:151]
  v_mfma_f32_16x16x32_bf16 v[148:151], a[228:231], v[200:203], v[148:151]
  s_waitcnt lgkmcnt(8)
  v_mfma_f32_16x16x32_bf16 v[148:151], a[244:247], v[204:207], v[148:151]
  buffer_load_dwordx4 v20, s[28:31], s61 offen offset:2048 lds
  v_mfma_f32_16x16x32_bf16 v[152:155], a[200:203], v[192:195], v[152:155]
  v_mfma_f32_16x16x32_bf16 v[152:155], a[216:219], v[196:199], v[152:155]
  v_mfma_f32_16x16x32_bf16 v[152:155], a[232:235], v[200:203], v[152:155]
  s_waitcnt lgkmcnt(6)
  buffer_load_dwordx4 v21, s[28:31], s61 offen offset:3072 lds
  v_fma_f32 v248, -v144, v144, s59
  v_mfma_f32_16x16x32_bf16 v[152:155], a[248:251], v[204:207], v[152:155]
  v_fma_f32 v249, -v145, v145, s59
  v_fma_f32 v250, -v146, v146, s59
  v_mfma_f32_16x16x32_bf16 v[156:159], a[204:207], v[192:195], v[156:159]
  v_fma_f32 v251, -v147, v147, s59
  v_mul_f32 v248, v248, v144
  v_mfma_f32_16x16x32_bf16 v[156:159], a[220:223], v[196:199], v[156:159]
  v_mul_f32 v249, v249, v145
  v_mul_f32 v250, v250, v146
  v_mfma_f32_16x16x32_bf16 v[156:159], a[236:239], v[200:203], v[156:159]
  s_waitcnt lgkmcnt(4)
  s_add_u32 m0, s47, 32768
  v_mul_f32 v251, v251, v147
  v_mul_f32 v148, v144, v148
  v_mfma_f32_16x16x32_bf16 v[156:159], a[252:255], v[204:207], v[156:159]
  s_waitcnt lgkmcnt(0)
  s_lshl4_add_u32 s61, s5, s18
  buffer_load_dwordx4 v18, s[28:31], s61 offen offset:0 lds
  v_mfma_f32_16x16x32_bf16 v[160:163], a[128:131], v[176:179], v[160:163]
  ds_read_b128 v[192:195], v31 offset:28672
  ds_read_b128 v[196:199], v31 offset:29696
  v_mfma_f32_16x16x32_bf16 v[160:163], a[144:147], v[180:183], v[160:163]
  v_exp_f32 v248, v248
  v_mfma_f32_16x16x32_bf16 v[160:163], a[160:163], v[184:187], v[160:163]
  ds_read_b128 v[200:203], v31 offset:30720
  ds_read_b128 v[204:207], v31 offset:31744
  v_mfma_f32_16x16x32_bf16 v[160:163], a[176:179], v[188:191], v[160:163]
  buffer_load_dwordx4 v19, s[28:31], s61 offen offset:1024 lds
  v_add_f32 v248, 1.0, v248
  v_mfma_f32_16x16x32_bf16 v[164:167], a[132:135], v[176:179], v[164:167]
  v_exp_f32 v249, v249
  v_mfma_f32_16x16x32_bf16 v[164:167], a[148:151], v[180:183], v[164:167]
  v_exp_f32 v250, v250
  v_mfma_f32_16x16x32_bf16 v[164:167], a[164:167], v[184:187], v[164:167]
  buffer_load_dwordx4 v20, s[28:31], s61 offen offset:2048 lds
  v_add_f32 v249, 1.0, v249
  v_mfma_f32_16x16x32_bf16 v[164:167], a[180:183], v[188:191], v[164:167]
  v_exp_f32 v251, v251
  v_mfma_f32_16x16x32_bf16 v[168:171], a[136:139], v[176:179], v[168:171]
  v_add_f32 v250, 1.0, v250
  v_add_f32 v251, 1.0, v251
  v_mfma_f32_16x16x32_bf16 v[168:171], a[152:155], v[180:183], v[168:171]
  buffer_load_dwordx4 v21, s[28:31], s61 offen offset:3072 lds
  v_mul_f32 v149, v145, v149
  v_mfma_f32_16x16x32_bf16 v[168:171], a[168:171], v[184:187], v[168:171]
  v_rcp_f32 v248, v248
  v_mfma_f32_16x16x32_bf16 v[168:171], a[184:187], v[188:191], v[168:171]
  v_rcp_f32 v249, v249
  v_mfma_f32_16x16x32_bf16 v[172:175], a[140:143], v[176:179], v[172:175]
  s_waitcnt vmcnt(13)
  ds_read_b64_tr_b16 v[32:33], v22 offset:16384
  v_mul_f32 v150, v146, v150
  v_mfma_f32_16x16x32_bf16 v[172:175], a[156:159], v[180:183], v[172:175]
  ds_read_b64_tr_b16 v[34:35], v22 offset:18432
  v_mul_f32 v151, v147, v151
  v_mfma_f32_16x16x32_bf16 v[172:175], a[172:175], v[184:187], v[172:175]
  ds_read_b64_tr_b16 v[36:37], v23 offset:16384
  v_mul_f32 v148, v148, v248
  v_mfma_f32_16x16x32_bf16 v[172:175], a[188:191], v[188:191], v[172:175]
  s_waitcnt lgkmcnt(3)
  s_waitcnt vmcnt(8)
  s_barrier
  ds_read_b64_tr_b16 v[38:39], v23 offset:18432
  v_mfma_f32_16x16x32_bf16 v[160:163], a[192:195], v[192:195], v[160:163]
  s_add_u32 m0, s47, 131072
  ds_read_b128 v[176:179], v243 offset:0
  ds_read_b128 v[180:183], v243 offset:1024
  v_mfma_f32_16x16x32_bf16 v[160:163], a[208:211], v[196:199], v[160:163]
  s_add_u32 s61, s66, 49152
  ds_read_b64_tr_b16 v[40:41], v24 offset:16384
  buffer_load_dwordx4 v242, s[32:35], s61 offen offset:0 sc1 lds
  v_mfma_f32_16x16x32_bf16 v[160:163], a[224:227], v[200:203], v[160:163]
  s_add_u32 m0, m0, 896
  ds_read_b128 v[184:187], v243 offset:2048
  ds_read_b128 v[188:191], v243 offset:3072
  v_mfma_f32_16x16x32_bf16 v[160:163], a[240:243], v[204:207], v[160:163]
  ds_read_b64_tr_b16 v[42:43], v24 offset:18432
  v_mul_f32 v149, v149, v249
  v_mfma_f32_16x16x32_bf16 v[164:167], a[196:199], v[192:195], v[164:167]
  ds_read_b64_tr_b16 v[44:45], v25 offset:16384
  buffer_load_dwordx4 v242, s[32:35], s61 offen offset:128 sc1 lds
  v_mfma_f32_16x16x32_bf16 v[164:167], a[212:215], v[196:199], v[164:167]
  s_add_u32 m0, m0, 896
  ds_read_b64_tr_b16 v[46:47], v25 offset:18432
  v_cvt_pk_bf16_f32 v244, v148, v149
  v_mfma_f32_16x16x32_bf16 v[164:167], a[228:231], v[200:203], v[164:167]
  v_rcp_f32 v250, v250
  v_mfma_f32_16x16x32_bf16 v[164:167], a[244:247], v[204:207], v[164:167]
  buffer_load_dwordx4 v242, s[32:35], s61 offen offset:256 sc1 lds
  v_mul_f32 v150, v150, v250
  v_mfma_f32_16x16x32_bf16 v[168:171], a[200:203], v[192:195], v[168:171]
  s_add_u32 m0, m0, 896
  v_cmp_ne_u64 vcc, s[48:49], v[14:15]
  v_mfma_f32_16x16x32_bf16 v[168:171], a[216:219], v[196:199], v[168:171]
  s_cbranch_vccnz L_f3b_re
L_f3b:
  v_rcp_f32 v251, v251
  v_mfma_f32_16x16x32_bf16 v[168:171], a[232:235], v[200:203], v[168:171]
  buffer_load_dwordx4 v242, s[32:35], s61 offen offset:384 sc1 lds
  v_mul_f32 v151, v151, v251
  v_mfma_f32_16x16x32_bf16 v[168:171], a[248:251], v[204:207], v[168:171]
  s_add_u32 m0, s47, 65536
  v_cvt_pk_bf16_f32 v245, v150, v151
  v_fma_f32 v252, -v152, v152, s59
  v_mfma_f32_16x16x32_bf16 v[172:175], a[204:207], v[192:195], v[172:175]
  s_lshl4_add_u32 s61, s5, s19
  v_fma_f32 v253, -v153, v153, s59
  v_fma_f32 v254, -v154, v154, s59
  v_mfma_f32_16x16x32_bf16 v[172:175], a[220:223], v[196:199], v[172:175]
  buffer_load_dwordx4 v18, s[28:31], s61 offen offset:0 lds
  v_fma_f32 v255, -v155, v155, s59
  v_mfma_f32_16x16x32_bf16 v[172:175], a[236:239], v[200:203], v[172:175]
  v_mul_f32 v252, v252, v152
  v_mul_f32 v253, v253, v153
  v_mfma_f32_16x16x32_bf16 v[172:175], a[252:255], v[204:207], v[172:175]
  s_waitcnt lgkmcnt(3)
  v_mul_f32 v254, v254, v154
  v_mul_f32 v255, v255, v155
  v_mfma_f32_16x16x32_bf16 v[128:131], a[0:3], v[176:179], 0
  ds_read_b128 v[192:195], v243 offset:4096
  ds_read_b128 v[196:199], v243 offset:5120
  v_mfma_f32_16x16x32_bf16 v[128:131], a[16:19], v[180:183], v[128:131]
  buffer_load_dwordx4 v19, s[28:31], s61 offen offset:1024 lds
  v_mul_f32 v156, v152, v156
  v_mfma_f32_16x16x32_bf16 v[128:131], a[32:35], v[184:187], v[128:131]
  ds_read_b128 v[200:203], v243 offset:6144
  ds_read_b128 v[204:207], v243 offset:7168
  v_mfma_f32_16x16x32_bf16 v[128:131], a[48:51], v[188:191], v[128:131]
  v_exp_f32 v252, v252
  v_mfma_f32_16x16x32_bf16 v[132:135], a[4:7], v[176:179], 0
  buffer_load_dwordx4 v20, s[28:31], s61 offen offset:2048 lds
  v_add_f32 v252, 1.0, v252
  v_mfma_f32_16x16x32_bf16 v[132:135], a[20:23], v[180:183], v[132:135]
  v_exp_f32 v253, v253
  v_mfma_f32_16x16x32_bf16 v[132:135], a[36:39], v[184:187], v[132:135]
  v_exp_f32 v254, v254
  v_mfma_f32_16x16x32_bf16 v[132:135], a[52:55], v[188:191], v[132:135]
  buffer_load_dwordx4 v21, s[28:31], s61 offen offset:3072 lds
  v_add_f32 v253, 1.0, v253
  v_mfma_f32_16x16x32_bf16 v[136:139], a[8:11], v[176:179], 0
  s_add_u32 m0, s47, 147456
  v_exp_f32 v255, v255
  v_mfma_f32_16x16x32_bf16 v[136:139], a[24:27], v[180:183], v[136:139]
  s_add_u32 s61, s67, 0
  v_add_f32 v254, 1.0, v254
  v_add_f32 v255, 1.0, v255
  v_mfma_f32_16x16x32_bf16 v[136:139], a[40:43], v[184:187], v[136:139]
  buffer_load_dwordx4 v242, s[32:35], s61 offen offset:0 sc1 lds
  v_mul_f32 v157, v153, v157
  v_mfma_f32_16x16x32_bf16 v[136:139], a[56:59], v[188:191], v[136:139]
  s_add_u32 m0, m0, 896
  v_rcp_f32 v252, v252
  v_mfma_f32_16x16x32_bf16 v[140:143], a[12:15], v[176:179], 0
  v_rcp_f32 v253, v253
  v_mfma_f32_16x16x32_bf16 v[140:143], a[28:31], v[180:183], v[140:143]
  buffer_load_dwordx4 v242, s[32:35], s61 offen offset:128 sc1 lds
  v_mul_f32 v158, v154, v158
  v_mfma_f32_16x16x32_bf16 v[140:143], a[44:47], v[184:187], v[140:143]
  s_add_u32 m0, m0, 896
  v_rcp_f32 v254, v254
  v_mfma_f32_16x16x32_bf16 v[140:143], a[60:63], v[188:191], v[140:143]
  s_waitcnt lgkmcnt(0)
  v_rcp_f32 v255, v255
  v_mfma_f32_16x16x32_bf16 v[128:131], a[64:67], v[192:195], v[128:131]
  s_add_u32 s58, s68, 0
  ds_read_b128 v[176:179], v243 offset:8192
  ds_read_b128 v[180:183], v243 offset:9216
  v_mfma_f32_16x16x32_bf16 v[128:131], a[80:83], v[196:199], v[128:131]
  buffer_load_dwordx4 v242, s[32:35], s61 offen offset:256 sc1 lds
  v_mul_f32 v159, v155, v159
  v_mfma_f32_16x16x32_bf16 v[128:131], a[96:99], v[200:203], v[128:131]
  s_add_u32 m0, m0, 896
  ds_read_b128 v[184:187], v243 offset:10240
  ds_read_b128 v[188:191], v243 offset:11264
  v_mfma_f32_16x16x32_bf16 v[128:131], a[112:115], v[204:207], v[128:131]
  v_mul_f32 v156, v156, v252
  v_mul_f32 v157, v157, v253
  v_mfma_f32_16x16x32_bf16 v[132:135], a[68:71], v[192:195], v[132:135]
  buffer_load_dwordx4 v242, s[32:35], s61 offen offset:384 sc1 lds
  v_mul_f32 v158, v158, v254
  v_mfma_f32_16x16x32_bf16 v[132:135], a[84:87], v[196:199], v[132:135]
  v_mul_f32 v159, v159, v255
  v_cvt_pk_bf16_f32 v246, v156, v157
  v_mfma_f32_16x16x32_bf16 v[132:135], a[100:103], v[200:203], v[132:135]
  v_cvt_pk_bf16_f32 v247, v158, v159
  v_fma_f32 v248, -v160, v160, s59
  v_mfma_f32_16x16x32_bf16 v[132:135], a[116:119], v[204:207], v[132:135]
  buffer_store_dwordx4 v[244:247], v17, s[32:35], s58 offen sc1
  v_mfma_f32_16x16x32_bf16 v[136:139], a[72:75], v[192:195], v[136:139]
  v_fma_f32 v249, -v161, v161, s59
  v_fma_f32 v250, -v162, v162, s59
  v_mfma_f32_16x16x32_bf16 v[136:139], a[88:91], v[196:199], v[136:139]
  v_fma_f32 v251, -v163, v163, s59
  v_mul_f32 v248, v248, v160
  v_mfma_f32_16x16x32_bf16 v[136:139], a[104:107], v[200:203], v[136:139]
  v_mul_f32 v249, v249, v161
  v_mul_f32 v250, v250, v162
  v_mfma_f32_16x16x32_bf16 v[136:139], a[120:123], v[204:207], v[136:139]
  v_mul_f32 v251, v251, v163
  v_mul_f32 v164, v160, v164
  v_mfma_f32_16x16x32_bf16 v[140:143], a[76:79], v[192:195], v[140:143]
  v_exp_f32 v248, v248
  v_mfma_f32_16x16x32_bf16 v[140:143], a[92:95], v[196:199], v[140:143]
  v_exp_f32 v249, v249
  v_mfma_f32_16x16x32_bf16 v[140:143], a[108:111], v[200:203], v[140:143]
  s_add_u32 m0, s47, 16384
  v_add_f32 v248, 1.0, v248
  v_mfma_f32_16x16x32_bf16 v[140:143], a[124:127], v[204:207], v[140:143]
  s_waitcnt lgkmcnt(0)
  s_lshl4_add_u32 s61, s6, s18
  buffer_load_dwordx4 v18, s[28:31], s61 offen offset:0 lds
  v_mfma_f32_16x16x32_bf16 v[128:131], a[128:131], v[176:179], v[128:131]
  ds_read_b128 v[192:195], v243 offset:12288
  ds_read_b128 v[196:199], v243 offset:13312
  v_mfma_f32_16x16x32_bf16 v[128:131], a[144:147], v[180:183], v[128:131]
  v_exp_f32 v250, v250
  v_mfma_f32_16x16x32_bf16 v[128:131], a[160:163], v[184:187], v[128:131]
  ds_read_b128 v[200:203], v243 offset:14336
  ds_read_b128 v[204:207], v243 offset:15360
  v_mfma_f32_16x16x32_bf16 v[128:131], a[176:179], v[188:191], v[128:131]
  buffer_load_dwordx4 v19, s[28:31], s61 offen offset:1024 lds
  v_add_f32 v249, 1.0, v249
  v_mfma_f32_16x16x32_bf16 v[132:135], a[132:135], v[176:179], v[132:135]
  v_exp_f32 v251, v251
  v_mfma_f32_16x16x32_bf16 v[132:135], a[148:151], v[180:183], v[132:135]
  v_add_f32 v250, 1.0, v250
  v_add_f32 v251, 1.0, v251
  v_mfma_f32_16x16x32_bf16 v[132:135], a[164:167], v[184:187], v[132:135]
  buffer_load_dwordx4 v20, s[28:31], s61 offen offset:2048 lds
  v_mul_f32 v165, v161, v165
  v_mfma_f32_16x16x32_bf16 v[132:135], a[180:183], v[188:191], v[132:135]
  v_rcp_f32 v248, v248
  v_mfma_f32_16x16x32_bf16 v[136:139], a[136:139], v[176:179], v[136:139]
  v_rcp_f32 v249, v249
  v_mfma_f32_16x16x32_bf16 v[136:139], a[152:155], v[180:183], v[136:139]
  buffer_load_dwordx4 v21, s[28:31], s61 offen offset:3072 lds
  v_mul_f32 v166, v162, v166
  v_mfma_f32_16x16x32_bf16 v[136:139], a[168:171], v[184:187], v[136:139]
  v_rcp_f32 v250, v250
  v_mfma_f32_16x16x32_bf16 v[136:139], a[184:187], v[188:191], v[136:139]
  v_rcp_f32 v251, v251
  v_mfma_f32_16x16x32_bf16 v[140:143], a[140:143], v[176:179], v[140:143]
  s_waitcnt vmcnt(17)
  ds_read_b64_tr_b16 v[48:49], v22 offset:32768
  v_mul_f32 v167, v163, v167
  v_mfma_f32_16x16x32_bf16 v[140:143], a[156:159], v[180:183], v[140:143]
  ds_read_b64_tr_b16 v[50:51], v22 offset:34816
  v_mul_f32 v164, v164, v248
  v_mfma_f32_16x16x32_bf16 v[140:143], a[172:175], v[184:187], v[140:143]
  ds_read_b64_tr_b16 v[52:53], v23 offset:32768
  v_mul_f32 v165, v165, v249
  v_mfma_f32_16x16x32_bf16 v[140:143], a[188:191], v[188:191], v[140:143]
  s_waitcnt lgkmcnt(3)
  s_waitcnt vmcnt(13)
  s_barrier
  ds_read_b64_tr_b16 v[54:55], v23 offset:34816
  v_mfma_f32_16x16x32_bf16 v[128:131], a[192:195], v[192:195], v[128:131]
  ds_read_b128 v[176:179], v31 offset:0
  ds_read_b128 v[180:183], v31 offset:1024
  v_mfma_f32_16x16x32_bf16 v[128:131], a[208:211], v[196:199], v[128:131]
  ds_read_b64_tr_b16 v[56:57], v24 offset:32768
  v_mul_f32 v166, v166, v250
  v_mfma_f32_16x16x32_bf16 v[128:131], a[224:227], v[200:203], v[128:131]
  s_add_u32 m0, s47, 81920
  ds_read_b128 v[184:187], v31 offset:2048
  ds_read_b128 v[188:191], v31 offset:3072
  v_mfma_f32_16x16x32_bf16 v[128:131], a[240:243], v[204:207], v[128:131]
  s_lshl4_add_u32 s61, s6, s19
  ds_read_b64_tr_b16 v[58:59], v24 offset:34816
  buffer_load_dwordx4 v18, s[28:31], s61 offen offset:0 lds
  v_mfma_f32_16x16x32_bf16 v[132:135], a[196:199], v[192:195], v[132:135]
  ds_read_b64_tr_b16 v[60:61], v25 offset:32768
  v_mul_f32 v167, v167, v251
  v_mfma_f32_16x16x32_bf16 v[132:135], a[212:215], v[196:199], v[132:135]
  ds_read_b64_tr_b16 v[62:63], v25 offset:34816
  v_cvt_pk_bf16_f32 v244, v164, v165
  v_mfma_f32_16x16x32_bf16 v[132:135], a[228:231], v[200:203], v[132:135]
  buffer_load_dwordx4 v19, s[28:31], s61 offen offset:1024 lds
  v_cvt_pk_bf16_f32 v245, v166, v167
  v_mfma_f32_16x16x32_bf16 v[132:135], a[244:247], v[204:207], v[132:135]
  v_fma_f32 v252, -v168, v168, s59
  v_fma_f32 v253, -v169, v169, s59
  v_mfma_f32_16x16x32_bf16 v[136:139], a[200:203], v[192:195], v[136:139]
  v_fma_f32 v254, -v170, v170, s59
  v_fma_f32 v255, -v171, v171, s59
  v_mfma_f32_16x16x32_bf16 v[136:139], a[216:219], v[196:199], v[136:139]
  buffer_load_dwordx4 v20, s[28:31], s61 offen offset:2048 lds
  v_mul_f32 v252, v252, v168
  v_mfma_f32_16x16x32_bf16 v[136:139], a[232:235], v[200:203], v[136:139]
  v_mul_f32 v253, v253, v169
  v_mul_f32 v254, v254, v170
  v_mfma_f32_16x16x32_bf16 v[136:139], a[248:251], v[204:207], v[136:139]
  v_mul_f32 v255, v255, v171
  v_mul_f32 v172, v168, v172
  v_mfma_f32_16x16x32_bf16 v[140:143], a[204:207], v[192:195], v[140:143]
  buffer_load_dwordx4 v21, s[28:31], s61 offen offset:3072 lds
  v_mul_f32 v173, v169, v173
  v_mfma_f32_16x16x32_bf16 v[140:143], a[220:223], v[196:199], v[140:143]
  v_exp_f32 v252, v252
  v_mfma_f32_16x16x32_bf16 v[140:143], a[236:239], v[200:203], v[140:143]
  v_exp_f32 v253, v253
  v_mfma_f32_16x16x32_bf16 v[140:143], a[252:255], v[204:207], v[140:143]
  s_waitcnt lgkmcnt(3)
  v_exp_f32 v254, v254
  v_mfma_f32_16x16x32_bf16 v[144:147], a[0:3], v[176:179], 0
  ds_read_b128 v[192:195], v31 offset:4096
  ds_read_b128 v[196:199], v31 offset:5120
  v_mfma_f32_16x16x32_bf16 v[144:147], a[16:19], v[180:183], v[144:147]
  v_exp_f32 v255, v255
  v_mfma_f32_16x16x32_bf16 v[144:147], a[32:35], v[184:187], v[144:147]
  ds_read_b128 v[200:203], v31 offset:6144
  ds_read_b128 v[204:207], v31 offset:7168
  v_mfma_f32_16x16x32_bf16 v[144:147], a[48:51], v[188:191], v[144:147]
  v_add_f32 v252, 1.0, v252
  v_add_f32 v253, 1.0, v253
  v_mfma_f32_16x16x32_bf16 v[148:151], a[4:7], v[176:179], 0
  v_add_f32 v254, 1.0, v254
  v_add_f32 v255, 1.0, v255
  v_mfma_f32_16x16x32_bf16 v[148:151], a[20:23], v[180:183], v[148:151]
  v_rcp_f32 v252, v252
  v_mfma_f32_16x16x32_bf16 v[148:151], a[36:39], v[184:187], v[148:151]
  v_rcp_f32 v253, v253
  v_mfma_f32_16x16x32_bf16 v[148:151], a[52:55], v[188:191], v[148:151]
  s_add_u32 s58, s68, 8192
  v_rcp_f32 v254, v254
  v_mfma_f32_16x16x32_bf16 v[152:155], a[8:11], v[176:179], 0
  s_add_u32 m0, s47, 0
  v_rcp_f32 v255, v255
  v_mfma_f32_16x16x32_bf16 v[152:155], a[24:27], v[180:183], v[152:155]
  s_add_u32 s61, s67, 16384
  buffer_load_dwordx4 v242, s[32:35], s61 offen offset:0 sc1 lds
  v_mul_f32 v174, v170, v174
  v_mfma_f32_16x16x32_bf16 v[152:155], a[40:43], v[184:187], v[152:155]
  s_add_u32 m0, m0, 896
  v_mul_f32 v175, v171, v175
  v_mul_f32 v172, v172, v252
  v_mfma_f32_16x16x32_bf16 v[152:155], a[56:59], v[188:191], v[152:155]
  v_mul_f32 v173, v173, v253
  v_mul_f32 v174, v174, v254
  v_mfma_f32_16x16x32_bf16 v[156:159], a[12:15], v[176:179], 0
  buffer_load_dwordx4 v242, s[32:35], s61 offen offset:128 sc1 lds
  v_mul_f32 v175, v175, v255
  v_mfma_f32_16x16x32_bf16 v[156:159], a[28:31], v[180:183], v[156:159]
  s_add_u32 m0, m0, 896
  v_cvt_pk_bf16_f32 v246, v172, v173
  v_cvt_pk_bf16_f32 v247, v174, v175
  v_mfma_f32_16x16x32_bf16 v[156:159], a[44:47], v[184:187], v[156:159]
  buffer_store_dwordx4 v[244:247], v17, s[32:35], s58 offen sc1
  v_mfma_f32_16x16x32_bf16 v[156:159], a[60:63], v[188:191], v[156:159]
  s_waitcnt lgkmcnt(0)
  buffer_load_dwordx4 v242, s[32:35], s61 offen offset:256 sc1 lds
  v_fma_f32 v248, -v128, v128, s59
  v_mfma_f32_16x16x32_bf16 v[144:147], a[64:67], v[192:195], v[144:147]
  s_add_u32 m0, m0, 896
  ds_read_b128 v[176:179], v31 offset:8192
  ds_read_b128 v[180:183], v31 offset:9216
  v_mfma_f32_16x16x32_bf16 v[144:147], a[80:83], v[196:199], v[144:147]
  v_fma_f32 v249, -v129, v129, s59
  v_fma_f32 v250, -v130, v130, s59
  v_mfma_f32_16x16x32_bf16 v[144:147], a[96:99], v[200:203], v[144:147]
  ds_read_b128 v[184:187], v31 offset:10240
  ds_read_b128 v[188:191], v31 offset:11264
  v_mfma_f32_16x16x32_bf16 v[144:147], a[112:115], v[204:207], v[144:147]
  buffer_load_dwordx4 v242, s[32:35], s61 offen offset:384 sc1 lds
  v_fma_f32 v251, -v131, v131, s59
  v_mfma_f32_16x16x32_bf16 v[148:151], a[68:71], v[192:195], v[148:151]
  v_mul_f32 v248, v248, v128
  v_mul_f32 v249, v249, v129
  v_mfma_f32_16x16x32_bf16 v[148:151], a[84:87], v[196:199], v[148:151]
  v_mul_f32 v250, v250, v130
  v_mul_f32 v251, v251, v131
  v_mfma_f32_16x16x32_bf16 v[148:151], a[100:103], v[200:203], v[148:151]
  v_exp_f32 v248, v248
  v_mfma_f32_16x16x32_bf16 v[148:151], a[116:119], v[204:207], v[148:151]
  v_exp_f32 v249, v249
  v_mfma_f32_16x16x32_bf16 v[152:155], a[72:75], v[192:195], v[152:155]
  v_exp_f32 v250, v250
  v_mfma_f32_16x16x32_bf16 v[152:155], a[88:91], v[196:199], v[152:155]
  v_exp_f32 v251, v251
  v_mfma_f32_16x16x32_bf16 v[152:155], a[104:107], v[200:203], v[152:155]
  v_add_f32 v248, 1.0, v248
  v_add_f32 v249, 1.0, v249
  v_mfma_f32_16x16x32_bf16 v[152:155], a[120:123], v[204:207], v[152:155]
  v_add_f32 v250, 1.0, v250
  v_add_f32 v251, 1.0, v251
  v_mfma_f32_16x16x32_bf16 v[156:159], a[76:79], v[192:195], v[156:159]
  v_rcp_f32 v248, v248
  v_mfma_f32_16x16x32_bf16 v[156:159], a[92:95], v[196:199], v[156:159]
  v_rcp_f32 v249, v249
  v_mfma_f32_16x16x32_bf16 v[156:159], a[108:111], v[200:203], v[156:159]
  s_add_u32 m0, s47, 32768
  v_mul_f32 v132, v128, v132
  v_mfma_f32_16x16x32_bf16 v[156:159], a[124:127], v[204:207], v[156:159]
  s_waitcnt lgkmcnt(0)
  s_lshl4_add_u32 s61, s7, s18
  buffer_load_dwordx4 v18, s[28:31], s61 offen offset:0 lds
  v_mfma_f32_16x16x32_bf16 v[144:147], a[128:131], v[176:179], v[144:147]
  ds_read_b128 v[192:195], v31 offset:12288
  ds_read_b128 v[196:199], v31 offset:13312
  v_mfma_f32_16x16x32_bf16 v[144:147], a[144:147], v[180:183], v[144:147]
  v_rcp_f32 v250, v250
  v_mfma_f32_16x16x32_bf16 v[144:147], a[160:163], v[184:187], v[144:147]
  ds_read_b128 v[200:203], v31 offset:14336
  ds_read_b128 v[204:207], v31 offset:15360
  v_mfma_f32_16x16x32_bf16 v[144:147], a[176:179], v[188:191], v[144:147]
  buffer_load_dwordx4 v19, s[28:31], s61 offen offset:1024 lds
  v_mul_f32 v133, v129, v133
  v_mfma_f32_16x16x32_bf16 v[148:151], a[132:135], v[176:179], v[148:151]
  v_rcp_f32 v251, v251
  v_mfma_f32_16x16x32_bf16 v[148:151], a[148:151], v[180:183], v[148:151]
  v_mul_f32 v134, v130, v134
  v_mul_f32 v135, v131, v135
  v_mfma_f32_16x16x32_bf16 v[148:151], a[164:167], v[184:187], v[148:151]
  buffer_load_dwordx4 v20, s[28:31], s61 offen offset:2048 lds
  v_mul_f32 v132, v132, v248
  v_mfma_f32_16x16x32_bf16 v[148:151], a[180:183], v[188:191], v[148:151]
  v_mul_f32 v133, v133, v249
  v_mul_f32 v134, v134, v250
  v_mfma_f32_16x16x32_bf16 v[152:155], a[136:139], v[176:179], v[152:155]
  v_mul_f32 v135, v135, v251
  v_cvt_pk_bf16_f32 v244, v132, v133
  v_mfma_f32_16x16x32_bf16 v[152:155], a[152:155], v[180:183], v[152:155]
  buffer_load_dwordx4 v21, s[28:31], s61 offen offset:3072 lds
  v_cvt_pk_bf16_f32 v245, v134, v135
  v_mfma_f32_16x16x32_bf16 v[152:155], a[168:171], v[184:187], v[152:155]
  v_fma_f32 v252, -v136, v136, s59
  v_fma_f32 v253, -v137, v137, s59
  v_mfma_f32_16x16x32_bf16 v[152:155], a[184:187], v[188:191], v[152:155]
  v_fma_f32 v254, -v138, v138, s59
  v_fma_f32 v255, -v139, v139, s59
  v_mfma_f32_16x16x32_bf16 v[156:159], a[140:143], v[176:179], v[156:159]
  s_waitcnt vmcnt(13)
  ds_read_b64_tr_b16 v[64:65], v22 offset:16384
  v_mul_f32 v252, v252, v136
  v_mfma_f32_16x16x32_bf16 v[156:159], a[156:159], v[180:183], v[156:159]
  ds_read_b64_tr_b16 v[66:67], v22 offset:18432
  v_mul_f32 v253, v253, v137
  v_mfma_f32_16x16x32_bf16 v[156:159], a[172:175], v[184:187], v[156:159]
  ds_read_b64_tr_b16 v[68:69], v23 offset:16384
  v_mul_f32 v254, v254, v138
  v_mfma_f32_16x16x32_bf16 v[156:159], a[188:191], v[188:191], v[156:159]
  s_waitcnt lgkmcnt(3)
  s_barrier
  ds_read_b64_tr_b16 v[70:71], v23 offset:18432
  v_mfma_f32_16x16x32_bf16 v[144:147], a[192:195], v[192:195], v[144:147]
L_page4:
  s_cbranch_execz L_hop456
  ds_read_b128 v[176:179], v31 offset:16384
  ds_read_b128 v[180:183], v31 offset:17408
  v_mfma_f32_16x16x32_bf16 v[144:147], a[208:211], v[196:199], v[144:147]
  ds_read_b64_tr_b16 v[72:73], v24 offset:16384
  v_mul_f32 v255, v255, v139
  v_mfma_f32_16x16x32_bf16 v[144:147], a[224:227], v[200:203], v[144:147]
  s_add_u32 m0, s47, 98304
  ds_read_b128 v[184:187], v31 offset:18432
  ds_read_b128 v[188:191], v31 offset:19456
  v_mfma_f32_16x16x32_bf16 v[144:147], a[240:243], v[204:207], v[144:147]
  s_lshl4_add_u32 s61, s7, s19
  ds_read_b64_tr_b16 v[74:75], v24 offset:18432
  buffer_load_dwordx4 v18, s[28:31], s61 offen offset:0 lds
  v_mfma_f32_16x16x32_bf16 v[148:151], a[196:199], v[192:195], v[148:151]
  ds_read_b64_tr_b16 v[76:77], v25 offset:16384
  v_mul_f32 v140, v136, v140
  v_mfma_f32_16x16x32_bf16 v[148:151], a[212:215], v[196:199], v[148:151]
  ds_read_b64_tr_b16 v[78:79], v25 offset:18432
  v_mul_f32 v141, v137, v141
  v_mfma_f32_16x16x32_bf16 v[148:151], a[228:231], v[200:203], v[148:151]
  buffer_load_dwordx4 v19, s[28:31], s61 offen offset:1024 lds
  v_mul_f32 v142, v138, v142
  v_mfma_f32_16x16x32_bf16 v[148:151], a[244:247], v[204:207], v[148:151]
  v_exp_f32 v252, v252
  v_mfma_f32_16x16x32_bf16 v[152:155], a[200:203], v[192:195], v[152:155]
  v_exp_f32 v253, v253
  v_mfma_f32_16x16x32_bf16 v[152:155], a[216:219], v[196:199], v[152:155]
  buffer_load_dwordx4 v20, s[28:31], s61 offen offset:2048 lds
  v_add_f32 v252, 1.0, v252
  v_mfma_f32_16x16x32_bf16 v[152:155], a[232:235], v[200:203], v[152:155]
  v_exp_f32 v254, v254
  v_mfma_f32_16x16x32_bf16 v[152:155], a[248:251], v[204:207], v[152:155]
  v_exp_f32 v255, v255
  v_mfma_f32_16x16x32_bf16 v[156:159], a[204:207], v[192:195], v[156:159]
  buffer_load_dwordx4 v21, s[28:31], s61 offen offset:3072 lds
  v_add_f32 v253, 1.0, v253
  v_mfma_f32_16x16x32_bf16 v[156:159], a[220:223], v[196:199], v[156:159]
  v_add_f32 v254, 1.0, v254
  v_add_f32 v255, 1.0, v255
  v_mfma_f32_16x16x32_bf16 v[156:159], a[236:239], v[200:203], v[156:159]
  v_rcp_f32 v252, v252
  v_mfma_f32_16x16x32_bf16 v[156:159], a[252:255], v[204:207], v[156:159]
  s_waitcnt lgkmcnt(3)
  v_rcp_f32 v253, v253
  v_mfma_f32_16x16x32_bf16 v[160:163], a[0:3], v[176:179], 0
  ds_read_b128 v[192:195], v31 offset:20480
  ds_read_b128 v[196:199], v31 offset:21504
  v_mfma_f32_16x16x32_bf16 v[160:163], a[16:19], v[180:183], v[160:163]
  s_add_u32 s58, s68, 114688
  v_rcp_f32 v254, v254
  v_mfma_f32_16x16x32_bf16 v[160:163], a[32:35], v[184:187], v[160:163]
  ds_read_b128 v[200:203], v31 offset:22528
  ds_read_b128 v[204:207], v31 offset:23552
  v_mfma_f32_16x16x32_bf16 v[160:163], a[48:51], v[188:191], v[160:163]
  v_rcp_f32 v255, v255
  v_mfma_f32_16x16x32_bf16 v[164:167], a[4:7], v[176:179], 0
  v_mul_f32 v143, v139, v143
  v_mul_f32 v140, v140, v252
  v_mfma_f32_16x16x32_bf16 v[164:167], a[20:23], v[180:183], v[164:167]
  v_mul_f32 v141, v141, v253
  v_mul_f32 v142, v142, v254
  v_mfma_f32_16x16x32_bf16 v[164:167], a[36:39], v[184:187], v[164:167]
  v_mul_f32 v143, v143, v255
  v_cvt_pk_bf16_f32 v246, v140, v141
  v_mfma_f32_16x16x32_bf16 v[164:167], a[52:55], v[188:191], v[164:167]
  v_cvt_pk_bf16_f32 v247, v142, v143
  v_fma_f32 v248, -v144, v144, s59
  v_mfma_f32_16x16x32_bf16 v[168:171], a[8:11], v[176:179], 0
  s_add_u32 m0, s47, 131072
  buffer_store_dwordx4 v[244:247], v17, s[32:35], s58 offen sc1
  v_mfma_f32_16x16x32_bf16 v[168:171], a[24:27], v[180:183], v[168:171]
  s_add_u32 s61, s67, 32768
  buffer_load_dwordx4 v242, s[32:35], s61 offen offset:0 sc1 lds
  v_fma_f32 v249, -v145, v145, s59
  v_mfma_f32_16x16x32_bf16 v[168:171], a[40:43], v[184:187], v[168:171]
  s_add_u32 m0, m0, 896
  v_fma_f32 v250, -v146, v146, s59
  v_fma_f32 v251, -v147, v147, s59
  v_mfma_f32_16x16x32_bf16 v[168:171], a[56:59], v[188:191], v[168:171]
  v_mul_f32 v248, v248, v144
  v_mul_f32 v249, v249, v145
  v_mfma_f32_16x16x32_bf16 v[172:175], a[12:15], v[176:179], 0
  buffer_load_dwordx4 v242, s[32:35], s61 offen offset:128 sc1 lds
  v_mul_f32 v250, v250, v146
  v_mfma_f32_16x16x32_bf16 v[172:175], a[28:31], v[180:183], v[172:175]
  s_add_u32 m0, m0, 896
  v_mul_f32 v251, v251, v147
  v_mul_f32 v148, v144, v148
  v_mfma_f32_16x16x32_bf16 v[172:175], a[44:47], v[184:187], v[172:175]
  v_exp_f32 v248, v248
  v_mfma_f32_16x16x32_bf16 v[172:175], a[60:63], v[188:191], v[172:175]
  s_waitcnt lgkmcnt(0)
  buffer_load_dwordx4 v242, s[32:35], s61 offen offset:256 sc1 lds
  v_add_f32 v248, 1.0, v248
  v_mfma_f32_16x16x32_bf16 v[160:163], a[64:67], v[192:195], v[160:163]
  s_add_u32 m0, m0, 896
  ds_read_b128 v[176:179], v31 offset:24576
  ds_read_b128 v[180:183], v31 offset:25600
  v_mfma_f32_16x16x32_bf16 v[160:163], a[80:83], v[196:199], v[160:163]
  v_exp_f32 v249, v249
  v_mfma_f32_16x16x32_bf16 v[160:163], a[96:99], v[200:203], v[160:163]
  ds_read_b128 v[184:187], v31 offset:26624
  ds_read_b128 v[188:191], v31 offset:27648
  v_mfma_f32_16x16x32_bf16 v[160:163], a[112:115], v[204:207], v[160:163]
  buffer_load_dwordx4 v242, s[32:35], s61 offen offset:384 sc1 lds
  v_add_f32 v249, 1.0, v249
  v_mfma_f32_16x16x32_bf16 v[164:167], a[68:71], v[192:195], v[164:167]
  v_exp_f32 v250, v250
  v_mfma_f32_16x16x32_bf16 v[164:167], a[84:87], v[196:199], v[164:167]
  v_exp_f32 v251, v251
  v_mfma_f32_16x16x32_bf16 v[164:167], a[100:103], v[200:203], v[164:167]
  v_add_f32 v250, 1.0, v250
  v_add_f32 v251, 1.0, v251
  v_mfma_f32_16x16x32_bf16 v[164:167], a[116:119], v[204:207], v[164:167]
  v_rcp_f32 v248, v248
  v_mfma_f32_16x16x32_bf16 v[168:171], a[72:75], v[192:195], v[168:171]
  v_rcp_f32 v249, v249
  v_mfma_f32_16x16x32_bf16 v[168:171], a[88:91], v[196:199], v[168:171]
  v_rcp_f32 v250, v250
  v_mfma_f32_16x16x32_bf16 v[168:171], a[104:107], v[200:203], v[168:171]
  v_rcp_f32 v251, v251
  v_mfma_f32_16x16x32_bf16 v[168:171], a[120:123], v[204:207], v[168:171]
  v_mul_f32 v149, v145, v149
  v_mul_f32 v150, v146, v150
  v_mfma_f32_16x16x32_bf16 v[172:175], a[76:79], v[192:195], v[172:175]
  v_mul_f32 v151, v147, v151
  v_mul_f32 v148, v148, v248
  v_mfma_f32_16x16x32_bf16 v[172:175], a[92:95], v[196:199], v[172:175]
  v_mul_f32 v149, v149, v249
  v_mul_f32 v150, v150, v250
  v_mfma_f32_16x16x32_bf16 v[172:175], a[108:111], v[200:203], v[172:175]
  s_add_u32 m0, s47, 16384
  v_mul_f32 v151, v151, v251
  v_mfma_f32_16x16x32_bf16 v[172:175], a[124:127], v[204:207], v[172:175]
  s_waitcnt lgkmcnt(0)
  s_lshl4_add_u32 s61, s8, s18
  buffer_load_dwordx4 v18, s[28:31], s61 offen offset:0 lds
  v_mfma_f32_16x16x32_bf16 v[160:163], a[128:131], v[176:179], v[160:163]
  ds_read_b128 v[192:195], v31 offset:28672
  ds_read_b128 v[196:199], v31 offset:29696
  v_mfma_f32_16x16x32_bf16 v[160:163], a[144:147], v[180:183], v[160:163]
  v_cvt_pk_bf16_f32 v244, v148, v149
  v_cvt_pk_bf16_f32 v245, v150, v151
  v_mfma_f32_16x16x32_bf16 v[160:163], a[160:163], v[184:187], v[160:163]
  ds_read_b128 v[200:203], v31 offset:30720
  ds_read_b128 v[204:207], v31 offset:31744
  v_mfma_f32_16x16x32_bf16 v[160:163], a[176:179], v[188:191], v[160:163]
  buffer_load_dwordx4 v19, s[28:31], s61 offen offset:1024 lds
  v_fma_f32 v252, -v152, v152, s59
  v_mfma_f32_16x16x32_bf16 v[164:167], a[132:135], v[176:179], v[164:167]
  v_fma_f32 v253, -v153, v153, s59
  v_fma_f32 v254, -v154, v154, s59
  v_mfma_f32_16x16x32_bf16 v[164:167], a[148:151], v[180:183], v[164:167]
  v_fma_f32 v255, -v155, v155, s59
  v_mul_f32 v252, v252, v152
  v_mfma_f32_16x16x32_bf16 v[164:167], a[164:167], v[184:187], v[164:167]
  buffer_load_dwordx4 v20, s[28:31], s61 offen offset:2048 lds
  v_mul_f32 v253, v253, v153
  v_mfma_f32_16x16x32_bf16 v[164:167], a[180:183], v[188:191], v[164:167]
  v_mul_f32 v254, v254, v154
  v_mul_f32 v255, v255, v155
  v_mfma_f32_16x16x32_bf16 v[168:171], a[136:139], v[176:179], v[168:171]
  v_exp_f32 v252, v252
  v_mfma_f32_16x16x32_bf16 v[168:171], a[152:155], v[180:183], v[168:171]
  buffer_load_dwordx4 v21, s[28:31], s61 offen offset:3072 lds
  v_add_f32 v252, 1.0, v252
  v_mfma_f32_16x16x32_bf16 v[168:171], a[168:171], v[184:187], v[168:171]
  v_exp_f32 v253, v253
  v_mfma_f32_16x16x32_bf16 v[168:171], a[184:187], v[188:191], v[168:171]
  v_exp_f32 v254, v254
  v_mfma_f32_16x16x32_bf16 v[172:175], a[140:143], v[176:179], v[172:175]
  s_waitcnt vmcnt(13)
  ds_read_b64_tr_b16 v[80:81], v22 offset:32768
  v_add_f32 v253, 1.0, v253
  v_mfma_f32_16x16x32_bf16 v[172:175], a[156:159], v[180:183], v[172:175]
  ds_read_b64_tr_b16 v[82:83], v22 offset:34816
  v_add_f32 v254, 1.0, v254
  v_mfma_f32_16x16x32_bf16 v[172:175], a[172:175], v[184:187], v[172:175]
  ds_read_b64_tr_b16 v[84:85], v23 offset:32768
  v_mul_f32 v156, v152, v156
  v_mfma_f32_16x16x32_bf16 v[172:175], a[188:191], v[188:191], v[172:175]
  s_waitcnt lgkmcnt(3)
  s_barrier
  ds_read_b64_tr_b16 v[86:87], v23 offset:34816
  v_mfma_f32_16x16x32_bf16 v[160:163], a[192:195], v[192:195], v[160:163]
  ds_read_b128 v[176:179], v243 offset:0
  ds_read_b128 v[180:183], v243 offset:1024
  v_mfma_f32_16x16x32_bf16 v[160:163], a[208:211], v[196:199], v[160:163]
  ds_read_b64_tr_b16 v[88:89], v24 offset:32768
  v_mul_f32 v157, v153, v157
  v_mfma_f32_16x16x32_bf16 v[160:163], a[224:227], v[200:203], v[160:163]
  s_add_u32 m0, s47, 114688
  ds_read_b128 v[184:187], v243 offset:2048
  ds_read_b128 v[188:191], v243 offset:3072
  v_mfma_f32_16x16x32_bf16 v[160:163], a[240:243], v[204:207], v[160:163]
  s_lshl4_add_u32 s61, s8, s19
  ds_read_b64_tr_b16 v[90:91], v24 offset:34816
  buffer_load_dwordx4 v18, s[28:31], s61 offen offset:0 lds
  v_mfma_f32_16x16x32_bf16 v[164:167], a[196:199], v[192:195], v[164:167]
  ds_read_b64_tr_b16 v[92:93], v25 offset:32768
  v_mul_f32 v158, v154, v158
  v_mfma_f32_16x16x32_bf16 v[164:167], a[212:215], v[196:199], v[164:167]
  ds_read_b64_tr_b16 v[94:95], v25 offset:34816
  v_mul_f32 v159, v155, v159
  v_mfma_f32_16x16x32_bf16 v[164:167], a[228:231], v[200:203], v[164:167]
  buffer_load_dwordx4 v19, s[28:31], s61 offen offset:1024 lds
  v_mfma_f32_16x16x32_bf16 v[164:167], a[244:247], v[204:207], v[164:167]
  v_exp_f32 v255, v255
  v_mfma_f32_16x16x32_bf16 v[168:171], a[200:203], v[192:195], v[168:171]
  v_add_f32 v255, 1.0, v255
  v_mfma_f32_16x16x32_bf16 v[168:171], a[216:219], v[196:199], v[168:171]
  buffer_load_dwordx4 v20, s[28:31], s61 offen offset:2048 lds
  v_mfma_f32_16x16x32_bf16 v[168:171], a[232:235], v[200:203], v[168:171]
  v_rcp_f32 v252, v252
  v_mfma_f32_16x16x32_bf16 v[168:171], a[248:251], v[204:207], v[168:171]
  v_rcp_f32 v253, v253
  v_mfma_f32_16x16x32_bf16 v[172:175], a[204:207], v[192:195], v[172:175]
  buffer_load_dwordx4 v21, s[28:31], s61 offen offset:3072 lds
  v_mul_f32 v156, v156, v252
  v_mfma_f32_16x16x32_bf16 v[172:175], a[220:223], v[196:199], v[172:175]
  s_add_u32 s58, s68, 122880
  v_rcp_f32 v254, v254
  v_mfma_f32_16x16x32_bf16 v[172:175], a[236:239], v[200:203], v[172:175]
  v_rcp_f32 v255, v255
  v_mfma_f32_16x16x32_bf16 v[172:175], a[252:255], v[204:207], v[172:175]
  s_waitcnt lgkmcnt(3)
  v_mul_f32 v157, v157, v253
  v_mul_f32 v158, v158, v254
  v_mfma_f32_16x16x32_bf16 v[128:131], a[0:3], v[176:179], 0
  ds_read_b128 v[192:195], v243 offset:4096
  ds_read_b128 v[196:199], v243 offset:5120
  v_mfma_f32_16x16x32_bf16 v[128:131], a[16:19], v[180:183], v[128:131]
  v_mul_f32 v159, v159, v255
  v_cvt_pk_bf16_f32 v246, v156, v157
  v_mfma_f32_16x16x32_bf16 v[128:131], a[32:35], v[184:187], v[128:131]
  ds_read_b128 v[200:203], v243 offset:6144
  ds_read_b128 v[204:207], v243 offset:7168
  v_mfma_f32_16x16x32_bf16 v[128:131], a[48:51], v[188:191], v[128:131]
  v_cvt_pk_bf16_f32 v247, v158, v159
  v_fma_f32 v248, -v160, v160, s59
  v_mfma_f32_16x16x32_bf16 v[132:135], a[4:7], v[176:179], 0
  buffer_store_dwordx4 v[244:247], v17, s[32:35], s58 offen sc1
  v_mfma_f32_16x16x32_bf16 v[132:135], a[20:23], v[180:183], v[132:135]
  v_fma_f32 v249, -v161, v161, s59
  v_fma_f32 v250, -v162, v162, s59
  v_mfma_f32_16x16x32_bf16 v[132:135], a[36:39], v[184:187], v[132:135]
  v_fma_f32 v251, -v163, v163, s59
  v_mul_f32 v248, v248, v160
  v_mfma_f32_16x16x32_bf16 v[132:135], a[52:55], v[188:191], v[132:135]
  v_mul_f32 v249, v249, v161
  v_mul_f32 v250, v250, v162
  v_mfma_f32_16x16x32_bf16 v[136:139], a[8:11], v[176:179], 0
  s_add_u32 m0, s47, 147456
  v_mul_f32 v251, v251, v163
  v_mul_f32 v164, v160, v164
  v_mfma_f32_16x16x32_bf16 v[136:139], a[24:27], v[180:183], v[136:139]
  s_add_u32 s61, s67, 49152
  buffer_load_dwordx4 v242, s[32:35], s61 offen offset:0 sc1 lds
  v_mul_f32 v165, v161, v165
  v_mfma_f32_16x16x32_bf16 v[136:139], a[40:43], v[184:187], v[136:139]
  s_add_u32 m0, m0, 896
  v_exp_f32 v248, v248
  v_mfma_f32_16x16x32_bf16 v[136:139], a[56:59], v[188:191], v[136:139]
  v_exp_f32 v249, v249
  v_mfma_f32_16x16x32_bf16 v[140:143], a[12:15], v[176:179], 0
  buffer_load_dwordx4 v242, s[32:35], s61 offen offset:128 sc1 lds
  v_add_f32 v248, 1.0, v248
  v_mfma_f32_16x16x32_bf16 v[140:143], a[28:31], v[180:183], v[140:143]
  s_add_u32 m0, m0, 896
  v_exp_f32 v250, v250
  v_mfma_f32_16x16x32_bf16 v[140:143], a[44:47], v[184:187], v[140:143]
  v_exp_f32 v251, v251
  v_mfma_f32_16x16x32_bf16 v[140:143], a[60:63], v[188:191], v[140:143]
  s_waitcnt lgkmcnt(0)
  buffer_load_dwordx4 v242, s[32:35], s61 offen offset:256 sc1 lds
  v_add_f32 v249, 1.0, v249
  v_mfma_f32_16x16x32_bf16 v[128:131], a[64:67], v[192:195], v[128:131]
  s_add_u32 m0, m0, 896
  ds_read_b128 v[176:179], v243 offset:8192
  ds_read_b128 v[180:183], v243 offset:9216
  v_mfma_f32_16x16x32_bf16 v[128:131], a[80:83], v[196:199], v[128:131]
  v_add_f32 v250, 1.0, v250
  v_add_f32 v251, 1.0, v251
  v_mfma_f32_16x16x32_bf16 v[128:131], a[96:99], v[200:203], v[128:131]
  ds_read_b128 v[184:187], v243 offset:10240
  ds_read_b128 v[188:191], v243 offset:11264
  v_mfma_f32_16x16x32_bf16 v[128:131], a[112:115], v[204:207], v[128:131]
  buffer_load_dwordx4 v242, s[32:35], s61 offen offset:384 sc1 lds
  v_mul_f32 v166, v162, v166
  v_mfma_f32_16x16x32_bf16 v[132:135], a[68:71], v[192:195], v[132:135]
  v_rcp_f32 v248, v248
  v_mfma_f32_16x16x32_bf16 v[132:135], a[84:87], v[196:199], v[132:135]
  v_rcp_f32 v249, v249
  v_mfma_f32_16x16x32_bf16 v[132:135], a[100:103], v[200:203], v[132:135]
  v_rcp_f32 v250, v250
  v_mfma_f32_16x16x32_bf16 v[132:135], a[116:119], v[204:207], v[132:135]
  v_rcp_f32 v251, v251
  v_mfma_f32_16x16x32_bf16 v[136:139], a[72:75], v[192:195], v[136:139]
  v_mul_f32 v167, v163, v167
  v_mul_f32 v164, v164, v248
  v_mfma_f32_16x16x32_bf16 v[136:139], a[88:91], v[196:199], v[136:139]
  v_mul_f32 v165, v165, v249
  v_mul_f32 v166, v166, v250
  v_mfma_f32_16x16x32_bf16 v[136:139], a[104:107], v[200:203], v[136:139]
  v_mul_f32 v167, v167, v251
  v_cvt_pk_bf16_f32 v244, v164, v165
  v_mfma_f32_16x16x32_bf16 v[136:139], a[120:123], v[204:207], v[136:139]
  v_cvt_pk_bf16_f32 v245, v166, v167
  v_fma_f32 v252, -v168, v168, s59
  v_mfma_f32_16x16x32_bf16 v[140:143], a[76:79], v[192:195], v[140:143]
  v_fma_f32 v253, -v169, v169, s59
  v_fma_f32 v254, -v170, v170, s59
  v_mfma_f32_16x16x32_bf16 v[140:143], a[92:95], v[196:199], v[140:143]
  v_fma_f32 v255, -v171, v171, s59
  v_mul_f32 v252, v252, v168
  v_mfma_f32_16x16x32_bf16 v[140:143], a[108:111], v[200:203], v[140:143]
  s_add_u32 m0, s47, 32768
  v_mul_f32 v253, v253, v169
  v_mfma_f32_16x16x32_bf16 v[140:143], a[124:127], v[204:207], v[140:143]
  s_waitcnt lgkmcnt(0)
  s_lshl4_add_u32 s61, s9, s18
  buffer_load_dwordx4 v18, s[28:31], s61 offen offset:0 lds
  v_mfma_f32_16x16x32_bf16 v[128:131], a[128:131], v[176:179], v[128:131]
  ds_read_b128 v[192:195], v243 offset:12288
  ds_read_b128 v[196:199], v243 offset:13312
  v_mfma_f32_16x16x32_bf16 v[128:131], a[144:147], v[180:183], v[128:131]
  v_mul_f32 v254, v254, v170
  v_mul_f32 v255, v255, v171
  v_mfma_f32_16x16x32_bf16 v[128:131], a[160:163], v[184:187], v[128:131]
  ds_read_b128 v[200:203], v243 offset:14336
  ds_read_b128 v[204:207], v243 offset:15360
  v_mfma_f32_16x16x32_bf16 v[128:131], a[176:179], v[188:191], v[128:131]
  buffer_load_dwordx4 v19, s[28:31], s61 offen offset:1024 lds
  v_mul_f32 v172, v168, v172
  v_mfma_f32_16x16x32_bf16 v[132:135], a[132:135], v[176:179], v[132:135]
  v_exp_f32 v252, v252
  v_mfma_f32_16x16x32_bf16 v[132:135], a[148:151], v[180:183], v[132:135]
  v_exp_f32 v253, v253
  v_mfma_f32_16x16x32_bf16 v[132:135], a[164:167], v[184:187], v[132:135]
  buffer_load_dwordx4 v20, s[28:31], s61 offen offset:2048 lds
  v_add_f32 v252, 1.0, v252
  v_mfma_f32_16x16x32_bf16 v[132:135], a[180:183], v[188:191], v[132:135]
  v_exp_f32 v254, v254
  v_mfma_f32_16x16x32_bf16 v[136:139], a[136:139], v[176:179], v[136:139]
  v_exp_f32 v255, v255
  v_mfma_f32_16x16x32_bf16 v[136:139], a[152:155], v[180:183], v[136:139]
  buffer_load_dwordx4 v21, s[28:31], s61 offen offset:3072 lds
  v_add_f32 v253, 1.0, v253
  v_mfma_f32_16x16x32_bf16 v[136:139], a[168:171], v[184:187], v[136:139]
  v_add_f32 v254, 1.0, v254
  v_add_f32 v255, 1.0, v255
  v_mfma_f32_16x16x32_bf16 v[136:139], a[184:187], v[188:191], v[136:139]
  v_rcp_f32 v252, v252
  v_mfma_f32_16x16x32_bf16 v[140:143], a[140:143], v[176:179], v[140:143]
  s_waitcnt vmcnt(13)
  ds_read_b64_tr_b16 v[96:97], v22 offset:16384
  v_mul_f32 v173, v169, v173
  v_mfma_f32_16x16x32_bf16 v[140:143], a[156:159], v[180:183], v[140:143]
  ds_read_b64_tr_b16 v[98:99], v22 offset:18432
  v_mul_f32 v174, v170, v174
  v_mfma_f32_16x16x32_bf16 v[140:143], a[172:175], v[184:187], v[140:143]
  ds_read_b64_tr_b16 v[100:101], v23 offset:16384
  v_mul_f32 v175, v171, v175
  v_mfma_f32_16x16x32_bf16 v[140:143], a[188:191], v[188:191], v[140:143]
  s_waitcnt lgkmcnt(3)
  s_barrier
  ds_read_b64_tr_b16 v[102:103], v23 offset:18432
  v_mfma_f32_16x16x32_bf16 v[128:131], a[192:195], v[192:195], v[128:131]
  ds_read_b128 v[176:179], v31 offset:0
  ds_read_b128 v[180:183], v31 offset:1024
  v_mfma_f32_16x16x32_bf16 v[128:131], a[208:211], v[196:199], v[128:131]
  ds_read_b64_tr_b16 v[104:105], v24 offset:16384
  v_mul_f32 v172, v172, v252
  v_mfma_f32_16x16x32_bf16 v[128:131], a[224:227], v[200:203], v[128:131]
  s_add_u32 m0, s47, 0
  ds_read_b128 v[184:187], v31 offset:2048
  ds_read_b128 v[188:191], v31 offset:3072
  v_mfma_f32_16x16x32_bf16 v[128:131], a[240:243], v[204:207], v[128:131]
  s_lshl4_add_u32 s61, s9, s19
  ds_read_b64_tr_b16 v[106:107], v24 offset:18432
  buffer_load_dwordx4 v18, s[28:31], s61 offen offset:0 lds
  v_mfma_f32_16x16x32_bf16 v[132:135], a[196:199], v[192:195], v[132:135]
  s_waitcnt vmcnt(9)
  ds_read_b64_tr_b16 v[108:109], v25 offset:16384
  s_cmp_eq_u32 s44, 0
  s_cbranch_scc1 L_slow3
  buffer_store_dwordx2 v[8:9], v30, s[32:35], s12 offen offset:0
L_back3:
  v_mfma_f32_16x16x32_bf16 v[132:135], a[212:215], v[196:199], v[132:135]
  ds_read_b64_tr_b16 v[110:111], v25 offset:18432
  v_mfma_f32_16x16x32_bf16 v[132:135], a[228:231], v[200:203], v[132:135]
  buffer_load_dwordx4 v19, s[28:31], s61 offen offset:1024 lds
  v_mfma_f32_16x16x32_bf16 v[132:135], a[244:247], v[204:207], v[132:135]
  s_add_u32 s58, s69, 0
  v_rcp_f32 v253, v253
  v_mfma_f32_16x16x32_bf16 v[136:139], a[200:203], v[192:195], v[136:139]
  v_rcp_f32 v254, v254
  v_mfma_f32_16x16x32_bf16 v[136:139], a[216:219], v[196:199], v[136:139]
  buffer_load_dwordx4 v20, s[28:31], s61 offen offset:2048 lds
  v_mul_f32 v173, v173, v253
  v_mfma_f32_16x16x32_bf16 v[136:139], a[232:235], v[200:203], v[136:139]
  v_rcp_f32 v255, v255
  v_mfma_f32_16x16x32_bf16 v[136:139], a[248:251], v[204:207], v[136:139]
  v_mul_f32 v174, v174, v254
  v_mul_f32 v175, v175, v255
  v_mfma_f32_16x16x32_bf16 v[140:143], a[204:207], v[192:195], v[140:143]
  buffer_load_dwordx4 v21, s[28:31], s61 offen offset:3072 lds
  v_cvt_pk_bf16_f32 v246, v172, v173
  v_mfma_f32_16x16x32_bf16 v[140:143], a[220:223], v[196:199], v[140:143]
  v_cvt_pk_bf16_f32 v247, v174, v175
  v_fma_f32 v248, -v128, v128, s59
  v_mfma_f32_16x16x32_bf16 v[140:143], a[236:239], v[200:203], v[140:143]
  buffer_store_dwordx4 v[244:247], v17, s[32:35], s58 offen sc1
  v_mfma_f32_16x16x32_bf16 v[140:143], a[252:255], v[204:207], v[140:143]
  s_waitcnt lgkmcnt(3)
  v_fma_f32 v249, -v129, v129, s59
  v_fma_f32 v250, -v130, v130, s59
  v_mfma_f32_16x16x32_bf16 v[144:147], a[0:3], v[176:179], 0
  ds_read_b128 v[192:195], v31 offset:4096
  ds_read_b128 v[196:199], v31 offset:5120
  v_mfma_f32_16x16x32_bf16 v[144:147], a[16:19], v[180:183], v[144:147]
  v_fma_f32 v251, -v131, v131, s59
  v_mul_f32 v248, v248, v128
  v_mfma_f32_16x16x32_bf16 v[144:147], a[32:35], v[184:187], v[144:147]
  ds_read_b128 v[200:203], v31 offset:6144
  ds_read_b128 v[204:207], v31 offset:7168
  v_mfma_f32_16x16x32_bf16 v[144:147], a[48:51], v[188:191], v[144:147]
  v_mul_f32 v249, v249, v129
  v_mul_f32 v250, v250, v130
  v_mfma_f32_16x16x32_bf16 v[148:151], a[4:7], v[176:179], 0
  v_mul_f32 v251, v251, v131
  v_mul_f32 v132, v128, v132
  v_mfma_f32_16x16x32_bf16 v[148:151], a[20:23], v[180:183], v[148:151]
  v_exp_f32 v248, v248
  v_mfma_f32_16x16x32_bf16 v[148:151], a[36:39], v[184:187], v[148:151]
  v_exp_f32 v249, v249
  v_mfma_f32_16x16x32_bf16 v[148:151], a[52:55], v[188:191], v[148:151]
  v_exp_f32 v250, v250
  v_mfma_f32_16x16x32_bf16 v[152:155], a[8:11], v[176:179], 0
  v_exp_f32 v251, v251
  v_mfma_f32_16x16x32_bf16 v[152:155], a[24:27], v[180:183], v[152:155]
  v_add_f32 v248, 1.0, v248
  v_add_f32 v249, 1.0, v249
  v_mfma_f32_16x16x32_bf16 v[152:155], a[40:43], v[184:187], v[152:155]
  v_add_f32 v250, 1.0, v250
  v_add_f32 v251, 1.0, v251
  v_mfma_f32_16x16x32_bf16 v[152:155], a[56:59], v[188:191], v[152:155]
  v_rcp_f32 v248, v248
  v_mfma_f32_16x16x32_bf16 v[156:159], a[12:15], v[176:179], 0
  v_rcp_f32 v249, v249
  v_mfma_f32_16x16x32_bf16 v[156:159], a[28:31], v[180:183], v[156:159]
  v_rcp_f32 v250, v250
  v_mfma_f32_16x16x32_bf16 v[156:159], a[44:47], v[184:187], v[156:159]
  v_rcp_f32 v251, v251
  v_mfma_f32_16x16x32_bf16 v[156:159], a[60:63], v[188:191], v[156:159]
  s_waitcnt lgkmcnt(0)
  v_mul_f32 v133, v129, v133
  v_mul_f32 v134, v130, v134
  v_mfma_f32_16x16x32_bf16 v[144:147], a[64:67], v[192:195], v[144:147]
  ds_read_b128 v[176:179], v31 offset:8192
  ds_read_b128 v[180:183], v31 offset:9216
  v_mfma_f32_16x16x32_bf16 v[144:147], a[80:83], v[196:199], v[144:147]
  v_mul_f32 v135, v131, v135
  v_mul_f32 v132, v132, v248
  v_mfma_f32_16x16x32_bf16 v[144:147], a[96:99], v[200:203], v[144:147]
  ds_read_b128 v[184:187], v31 offset:10240
  ds_read_b128 v[188:191], v31 offset:11264
  v_mfma_f32_16x16x32_bf16 v[144:147], a[112:115], v[204:207], v[144:147]
  v_mul_f32 v133, v133, v249
  v_mul_f32 v134, v134, v250
  v_mfma_f32_16x16x32_bf16 v[148:151], a[68:71], v[192:195], v[148:151]
  v_mul_f32 v135, v135, v251
  v_cvt_pk_bf16_f32 v244, v132, v133
  v_mfma_f32_16x16x32_bf16 v[148:151], a[84:87], v[196:199], v[148:151]
  v_cvt_pk_bf16_f32 v245, v134, v135
  v_fma_f32 v252, -v136, v136, s59
  v_mfma_f32_16x16x32_bf16 v[148:151], a[100:103], v[200:203], v[148:151]
  v_fma_f32 v253, -v137, v137, s59
  v_fma_f32 v254, -v138, v138, s59
  v_mfma_f32_16x16x32_bf16 v[148:151], a[116:119], v[204:207], v[148:151]
  v_fma_f32 v255, -v139, v139, s59
  v_mul_f32 v252, v252, v136
  v_mfma_f32_16x16x32_bf16 v[152:155], a[72:75], v[192:195], v[152:155]
  v_mul_f32 v253, v253, v137
  v_mul_f32 v254, v254, v138
  v_mfma_f32_16x16x32_bf16 v[152:155], a[88:91], v[196:199], v[152:155]
  v_mul_f32 v255, v255, v139
  v_mul_f32 v140, v136, v140
  v_mfma_f32_16x16x32_bf16 v[152:155], a[104:107], v[200:203], v[152:155]
  v_exp_f32 v252, v252
  v_mfma_f32_16x16x32_bf16 v[152:155], a[120:123], v[204:207], v[152:155]
  v_exp_f32 v253, v253
  v_mfma_f32_16x16x32_bf16 v[156:159], a[76:79], v[192:195], v[156:159]
  v_exp_f32 v254, v254
  v_mfma_f32_16x16x32_bf16 v[156:159], a[92:95], v[196:199], v[156:159]
  v_exp_f32 v255, v255
  v_mfma_f32_16x16x32_bf16 v[156:159], a[108:111], v[200:203], v[156:159]
  s_add_u32 m0, s47, 16384
  v_add_f32 v252, 1.0, v252
  v_mfma_f32_16x16x32_bf16 v[156:159], a[124:127], v[204:207], v[156:159]
  s_waitcnt lgkmcnt(0)
  s_lshl4_add_u32 s61, s10, s18
  buffer_load_dwordx4 v18, s[28:31], s61 offen offset:0 lds
  v_mfma_f32_16x16x32_bf16 v[144:147], a[128:131], v[176:179], v[144:147]
  ds_read_b128 v[192:195], v31 offset:12288
  ds_read_b128 v[196:199], v31 offset:13312
  v_mfma_f32_16x16x32_bf16 v[144:147], a[144:147], v[180:183], v[144:147]
  buffer_load_dwordx2 v[12:13], v16, s[32:35], s14 offen offset:0 sc1
  v_add_f32 v253, 1.0, v253
  v_mfma_f32_16x16x32_bf16 v[144:147], a[160:163], v[184:187], v[144:147]
  ds_read_b128 v[200:203], v31 offset:14336
  ds_read_b128 v[204:207], v31 offset:15360
  v_mfma_f32_16x16x32_bf16 v[144:147], a[176:179], v[188:191], v[144:147]
  buffer_load_dwordx4 v19, s[28:31], s61 offen offset:1024 lds
  v_add_f32 v254, 1.0, v254
  v_mfma_f32_16x16x32_bf16 v[148:151], a[132:135], v[176:179], v[148:151]
  v_add_f32 v255, 1.0, v255
  v_mul_f32 v141, v137, v141
  v_mfma_f32_16x16x32_bf16 v[148:151], a[148:151], v[180:183], v[148:151]
  v_rcp_f32 v252, v252
  v_mfma_f32_16x16x32_bf16 v[148:151], a[164:167], v[184:187], v[148:151]
  buffer_load_dwordx4 v20, s[28:31], s61 offen offset:2048 lds
  v_mul_f32 v142, v138, v142
  v_mfma_f32_16x16x32_bf16 v[148:151], a[180:183], v[188:191], v[148:151]
  v_rcp_f32 v253, v253
  v_mfma_f32_16x16x32_bf16 v[152:155], a[136:139], v[176:179], v[152:155]
  v_rcp_f32 v254, v254
  v_mfma_f32_16x16x32_bf16 v[152:155], a[152:155], v[180:183], v[152:155]
  buffer_load_dwordx4 v21, s[28:31], s61 offen offset:3072 lds
  v_mul_f32 v143, v139, v143
  v_mfma_f32_16x16x32_bf16 v[152:155], a[168:171], v[184:187], v[152:155]
  v_rcp_f32 v255, v255
  v_mfma_f32_16x16x32_bf16 v[152:155], a[184:187], v[188:191], v[152:155]
  v_mul_f32 v140, v140, v252
  v_mul_f32 v141, v141, v253
  v_mfma_f32_16x16x32_bf16 v[156:159], a[140:143], v[176:179], v[156:159]
  s_waitcnt vmcnt(11)
  ds_read_b64_tr_b16 v[112:113], v22 offset:32768
  v_mul_f32 v142, v142, v254
  v_mfma_f32_16x16x32_bf16 v[156:159], a[156:159], v[180:183], v[156:159]
  ds_read_b64_tr_b16 v[114:115], v22 offset:34816
  v_mul_f32 v143, v143, v255
  v_mfma_f32_16x16x32_bf16 v[156:159], a[172:175], v[184:187], v[156:159]
  ds_read_b64_tr_b16 v[116:117], v23 offset:32768
  v_cvt_pk_bf16_f32 v246, v140, v141
  v_mfma_f32_16x16x32_bf16 v[156:159], a[188:191], v[188:191], v[156:159]
  s_waitcnt lgkmcnt(3)
  s_barrier
  ds_read_b64_tr_b16 v[118:119], v23 offset:34816
  v_mfma_f32_16x16x32_bf16 v[144:147], a[192:195], v[192:195], v[144:147]
  ds_read_b128 v[176:179], v31 offset:16384
  ds_read_b128 v[180:183], v31 offset:17408
  v_mfma_f32_16x16x32_bf16 v[144:147], a[208:211], v[196:199], v[144:147]
  ds_read_b64_tr_b16 v[120:121], v24 offset:32768
  v_lshrrev_b32 v4, 1, v3
  v_mfma_f32_16x16x32_bf16 v[144:147], a[224:227], v[200:203], v[144:147]
  s_add_u32 m0, s47, 131072
  ds_read_b128 v[184:187], v31 offset:18432
  ds_read_b128 v[188:191], v31 offset:19456
  v_mfma_f32_16x16x32_bf16 v[144:147], a[240:243], v[204:207], v[144:147]
  s_lshl4_add_u32 s61, s10, s19
  ds_read_b64_tr_b16 v[122:123], v24 offset:34816
  buffer_load_dwordx4 v18, s[28:31], s61 offen offset:0 lds
  v_mfma_f32_16x16x32_bf16 v[148:151], a[196:199], v[192:195], v[148:151]
  s_add_u32 s58, s69, 8192
  ds_read_b64_tr_b16 v[124:125], v25 offset:32768
  v_and_b32 v5, 1, v3
  v_mfma_f32_16x16x32_bf16 v[148:151], a[212:215], v[196:199], v[148:151]
  ds_read_b64_tr_b16 v[126:127], v25 offset:34816
  v_lshlrev_b32 v4, 14, v4
  v_mfma_f32_16x16x32_bf16 v[148:151], a[228:231], v[200:203], v[148:151]
  buffer_load_dwordx4 v19, s[28:31], s61 offen offset:1024 lds
  v_lshl_add_u32 v4, v5, 11, v4
  v_mfma_f32_16x16x32_bf16 v[148:151], a[244:247], v[204:207], v[148:151]
  s_waitcnt vmcnt(5)
  v_cmp_ne_u64 vcc, s[48:49], v[12:13]
  v_lshl_add_u32 v4, v2, 4, v4
  v_mfma_f32_16x16x32_bf16 v[152:155], a[200:203], v[192:195], v[152:155]
  s_cbranch_vccnz L_f40_re
L_f40:
  v_add_u32 v7, 31744, v4
  v_lshlrev_b32 v5, 2, v2
  v_mfma_f32_16x16x32_bf16 v[152:155], a[216:219], v[196:199], v[152:155]
  s_add_u32 s52, s16, 0
  buffer_load_dwordx4 v20, s[28:31], s61 offen offset:2048 lds
  v_lshl_add_u32 v5, v3, 8, v5
  v_mfma_f32_16x16x32_bf16 v[152:155], a[232:235], v[200:203], v[152:155]
  v_add_u32 v241, s52, v17
  v_cvt_pk_bf16_f32 v247, v142, v143
  v_mfma_f32_16x16x32_bf16 v[152:155], a[248:251], v[204:207], v[152:155]
  buffer_store_dwordx4 v[244:247], v17, s[32:35], s58 offen sc1
  v_mfma_f32_16x16x32_bf16 v[156:159], a[204:207], v[192:195], v[156:159]
  buffer_load_dwordx4 v21, s[28:31], s61 offen offset:3072 lds
  v_fma_f32 v248, -v144, v144, s59
  v_mfma_f32_16x16x32_bf16 v[156:159], a[220:223], v[196:199], v[156:159]
  s_waitcnt lgkmcnt(0)
  s_add_u32 m0, s47, 32768
  v_fma_f32 v249, -v145, v145, s59
  v_mfma_f32_16x16x32_bf16 v[156:159], a[236:239], v[200:203], v[156:159]
  buffer_load_dwordx4 v4, s[32:35], s15 offen sc1 lds
  v_fma_f32 v250, -v146, v146, s59
  v_mfma_f32_16x16x32_bf16 v[156:159], a[252:255], v[204:207], v[156:159]
  v_fma_f32 v251, -v147, v147, s59
  v_mul_f32 v248, v248, v144
  v_mfma_f32_16x16x32_bf16 v[160:163], a[0:3], v[176:179], 0
  ds_read_b128 v[192:195], v31 offset:20480
  ds_read_b128 v[196:199], v31 offset:21504
  v_mfma_f32_16x16x32_bf16 v[160:163], a[16:19], v[180:183], v[160:163]
  buffer_load_dwordx4 v7, s[32:35], s15 offen offset:1024 sc1 lds
  v_mul_f32 v249, v249, v145
  v_mfma_f32_16x16x32_bf16 v[160:163], a[32:35], v[184:187], v[160:163]
  ds_read_b128 v[200:203], v31 offset:22528
  ds_read_b128 v[204:207], v31 offset:23552
  v_mfma_f32_16x16x32_bf16 v[160:163], a[48:51], v[188:191], v[160:163]
  buffer_load_dword v5, s[32:35], s11 offen offset:2048 sc1 lds
  v_mul_f32 v250, v250, v146
  v_mfma_f32_16x16x32_bf16 v[164:167], a[4:7], v[176:179], 0
L_page5:
  s_cbranch_execz L_hop456
  v_mul_f32 v251, v251, v147
  v_mul_f32 v148, v144, v148
  v_mfma_f32_16x16x32_bf16 v[164:167], a[20:23], v[180:183], v[164:167]
  buffer_load_dwordx4 v[208:211], v241, s[32:35], s4 offen sc1
  v_mul_f32 v149, v145, v149
  v_mfma_f32_16x16x32_bf16 v[164:167], a[36:39], v[184:187], v[164:167]
  v_exp_f32 v248, v248
  v_mfma_f32_16x16x32_bf16 v[164:167], a[52:55], v[188:191], v[164:167]
  v_exp_f32 v249, v249
  v_mfma_f32_16x16x32_bf16 v[168:171], a[8:11], v[176:179], 0
  v_exp_f32 v250, v250
  v_mfma_f32_16x16x32_bf16 v[168:171], a[24:27], v[180:183], v[168:171]
  v_exp_f32 v251, v251
  v_mfma_f32_16x16x32_bf16 v[168:171], a[40:43], v[184:187], v[168:171]
  buffer_load_dwordx4 v[212:215], v241, s[32:35], s5 offen sc1
  v_add_f32 v248, 1.0, v248
  v_mfma_f32_16x16x32_bf16 v[168:171], a[56:59], v[188:191], v[168:171]
  v_add_f32 v249, 1.0, v249
  v_add_f32 v250, 1.0, v250
  v_mfma_f32_16x16x32_bf16 v[172:175], a[12:15], v[176:179], 0
  v_add_f32 v251, 1.0, v251
  v_mul_f32 v150, v146, v150
  v_mfma_f32_16x16x32_bf16 v[172:175], a[28:31], v[180:183], v[172:175]
  v_rcp_f32 v248, v248
  v_mfma_f32_16x16x32_bf16 v[172:175], a[44:47], v[184:187], v[172:175]
  buffer_load_dwordx4 v[216:219], v241, s[32:35], s6 offen sc1
  v_mul_f32 v151, v147, v151
  v_mfma_f32_16x16x32_bf16 v[172:175], a[60:63], v[188:191], v[172:175]
  s_waitcnt lgkmcnt(0)
  v_rcp_f32 v249, v249
  v_mfma_f32_16x16x32_bf16 v[160:163], a[64:67], v[192:195], v[160:163]
  ds_read_b128 v[176:179], v31 offset:24576
  ds_read_b128 v[180:183], v31 offset:25600
  v_mfma_f32_16x16x32_bf16 v[160:163], a[80:83], v[196:199], v[160:163]
  v_rcp_f32 v250, v250
  v_mfma_f32_16x16x32_bf16 v[160:163], a[96:99], v[200:203], v[160:163]
  ds_read_b128 v[184:187], v31 offset:26624
  ds_read_b128 v[188:191], v31 offset:27648
  v_mfma_f32_16x16x32_bf16 v[160:163], a[112:115], v[204:207], v[160:163]
  buffer_load_dwordx4 a[0:3], v241, s[32:35], s7 offen sc1
  v_mul_f32 v148, v148, v248
  v_mfma_f32_16x16x32_bf16 v[164:167], a[68:71], v[192:195], v[164:167]
  v_rcp_f32 v251, v251
  v_mfma_f32_16x16x32_bf16 v[164:167], a[84:87], v[196:199], v[164:167]
  v_mul_f32 v149, v149, v249
  v_mul_f32 v150, v150, v250
  v_mfma_f32_16x16x32_bf16 v[164:167], a[100:103], v[200:203], v[164:167]
  v_mul_f32 v151, v151, v251
  v_cvt_pk_bf16_f32 v244, v148, v149
  v_mfma_f32_16x16x32_bf16 v[164:167], a[116:119], v[204:207], v[164:167]
  buffer_load_dwordx4 a[4:7], v241, s[32:35], s8 offen sc1
  v_cvt_pk_bf16_f32 v245, v150, v151
  v_mfma_f32_16x16x32_bf16 v[168:171], a[72:75], v[192:195], v[168:171]
  v_fma_f32 v252, -v152, v152, s59
  v_fma_f32 v253, -v153, v153, s59
  v_mfma_f32_16x16x32_bf16 v[168:171], a[88:91], v[196:199], v[168:171]
  v_fma_f32 v254, -v154, v154, s59
  v_fma_f32 v255, -v155, v155, s59
  v_mfma_f32_16x16x32_bf16 v[168:171], a[104:107], v[200:203], v[168:171]
  v_mul_f32 v252, v252, v152
  v_mul_f32 v253, v253, v153
  v_mfma_f32_16x16x32_bf16 v[168:171], a[120:123], v[204:207], v[168:171]
  v_mul_f32 v254, v254, v154
  v_mul_f32 v255, v255, v155
  v_mfma_f32_16x16x32_bf16 v[172:175], a[76:79], v[192:195], v[172:175]
  buffer_load_dwordx4 a[8:11], v241, s[32:35], s9 offen sc1
  v_mul_f32 v156, v152, v156
  v_mfma_f32_16x16x32_bf16 v[172:175], a[92:95], v[196:199], v[172:175]
  v_exp_f32 v252, v252
  v_mfma_f32_16x16x32_bf16 v[172:175], a[108:111], v[200:203], v[172:175]
  v_exp_f32 v253, v253
  v_mfma_f32_16x16x32_bf16 v[172:175], a[124:127], v[204:207], v[172:175]
  s_waitcnt lgkmcnt(0)
  v_exp_f32 v254, v254
  v_mfma_f32_16x16x32_bf16 v[160:163], a[128:131], v[176:179], v[160:163]
  ds_read_b128 v[192:195], v31 offset:28672
  ds_read_b128 v[196:199], v31 offset:29696
  v_mfma_f32_16x16x32_bf16 v[160:163], a[144:147], v[180:183], v[160:163]
  buffer_load_dwordx4 a[12:15], v241, s[32:35], s10 offen sc1
  v_add_f32 v252, 1.0, v252
  v_mfma_f32_16x16x32_bf16 v[160:163], a[160:163], v[184:187], v[160:163]
  ds_read_b128 v[200:203], v31 offset:30720
  ds_read_b128 v[204:207], v31 offset:31744
  v_mfma_f32_16x16x32_bf16 v[160:163], a[176:179], v[188:191], v[160:163]
  v_exp_f32 v255, v255
  v_mfma_f32_16x16x32_bf16 v[164:167], a[132:135], v[176:179], v[164:167]
  v_add_f32 v253, 1.0, v253
  v_add_f32 v254, 1.0, v254
  v_mfma_f32_16x16x32_bf16 v[164:167], a[148:151], v[180:183], v[164:167]
  s_add_u32 s52, s16, 8192
  v_add_u32 v241, s52, v17
  v_add_f32 v255, 1.0, v255
  v_mfma_f32_16x16x32_bf16 v[164:167], a[164:167], v[184:187], v[164:167]
  buffer_load_dwordx4 a[16:19], v241, s[32:35], s4 offen sc1
  v_mul_f32 v157, v153, v157
  v_mfma_f32_16x16x32_bf16 v[164:167], a[180:183], v[188:191], v[164:167]
  v_rcp_f32 v252, v252
  v_mfma_f32_16x16x32_bf16 v[168:171], a[136:139], v[176:179], v[168:171]
  v_rcp_f32 v253, v253
  v_mfma_f32_16x16x32_bf16 v[168:171], a[152:155], v[180:183], v[168:171]
  v_rcp_f32 v254, v254
  v_mfma_f32_16x16x32_bf16 v[168:171], a[168:171], v[184:187], v[168:171]
  buffer_load_dwordx4 a[20:23], v241, s[32:35], s5 offen sc1
  v_mul_f32 v158, v154, v158
  v_mfma_f32_16x16x32_bf16 v[168:171], a[184:187], v[188:191], v[168:171]
  s_waitcnt vmcnt(13)
  s_cmp_eq_u32 s44, 0
  s_cbranch_scc1 L_slow4
  buffer_store_dwordx2 v[8:9], v30, s[32:35], s13 offen offset:128
L_back4:
  v_mfma_f32_16x16x32_bf16 v[172:175], a[140:143], v[176:179], v[172:175]
  ds_read_b64_tr_b16 v[128:129], v22 offset:16384
  v_mul_f32 v159, v155, v159
  v_mfma_f32_16x16x32_bf16 v[172:175], a[156:159], v[180:183], v[172:175]
  ds_read_b64_tr_b16 v[130:131], v22 offset:18432
  v_mul_f32 v156, v156, v252
  v_mfma_f32_16x16x32_bf16 v[172:175], a[172:175], v[184:187], v[172:175]
  ds_read_b64_tr_b16 v[132:133], v23 offset:16384
  v_mul_f32 v157, v157, v253
  v_mfma_f32_16x16x32_bf16 v[172:175], a[188:191], v[188:191], v[172:175]
  s_waitcnt lgkmcnt(3)
  ds_read_b64_tr_b16 v[134:135], v23 offset:18432
  buffer_load_dwordx4 a[24:27], v241, s[32:35], s6 offen sc1
  v_mfma_f32_16x16x32_bf16 v[160:163], a[192:195], v[192:195], v[160:163]
  s_add_u32 s58, s69, 114688
  ds_read_b64_tr_b16 v[136:137], v24 offset:16384
  v_mul_f32 v158, v158, v254
  v_mfma_f32_16x16x32_bf16 v[160:163], a[208:211], v[196:199], v[160:163]
  ds_read_b64_tr_b16 v[138:139], v24 offset:18432
  v_cvt_pk_bf16_f32 v246, v156, v157
  v_mfma_f32_16x16x32_bf16 v[160:163], a[224:227], v[200:203], v[160:163]
  ds_read_b64_tr_b16 v[140:141], v25 offset:16384
  v_mfma_f32_16x16x32_bf16 v[160:163], a[240:243], v[204:207], v[160:163]
  ds_read_b64_tr_b16 v[142:143], v25 offset:18432
  buffer_load_dwordx4 a[28:31], v241, s[32:35], s7 offen sc1
  v_mfma_f32_16x16x32_bf16 v[164:167], a[196:199], v[192:195], v[164:167]
  v_rcp_f32 v255, v255
  v_mfma_f32_16x16x32_bf16 v[164:167], a[212:215], v[196:199], v[164:167]
  v_mul_f32 v159, v159, v255
  v_cvt_pk_bf16_f32 v247, v158, v159
  v_mfma_f32_16x16x32_bf16 v[164:167], a[228:231], v[200:203], v[164:167]
  buffer_store_dwordx4 v[244:247], v17, s[32:35], s58 offen sc1
  v_mfma_f32_16x16x32_bf16 v[164:167], a[244:247], v[204:207], v[164:167]
  v_mfma_f32_16x16x32_bf16 v[168:171], a[200:203], v[192:195], v[168:171]
  buffer_load_dwordx4 a[32:35], v241, s[32:35], s8 offen sc1
  v_mfma_f32_16x16x32_bf16 v[168:171], a[216:219], v[196:199], v[168:171]
  v_mfma_f32_16x16x32_bf16 v[168:171], a[232:235], v[200:203], v[168:171]
  v_fma_f32 v248, -v160, v160, s59
  v_fma_f32 v249, -v161, v161, s59
  v_mfma_f32_16x16x32_bf16 v[168:171], a[248:251], v[204:207], v[168:171]
  v_fma_f32 v250, -v162, v162, s59
  v_fma_f32 v251, -v163, v163, s59
  v_mfma_f32_16x16x32_bf16 v[172:175], a[204:207], v[192:195], v[172:175]
  buffer_load_dwordx4 a[36:39], v241, s[32:35], s9 offen sc1
  v_mul_f32 v248, v248, v160
  v_mfma_f32_16x16x32_bf16 v[172:175], a[220:223], v[196:199], v[172:175]
  v_mul_f32 v249, v249, v161
  v_mul_f32 v250, v250, v162
  v_mfma_f32_16x16x32_bf16 v[172:175], a[236:239], v[200:203], v[172:175]
  v_mul_f32 v251, v251, v163
  v_mul_f32 v164, v160, v164
  v_mfma_f32_16x16x32_bf16 v[172:175], a[252:255], v[204:207], v[172:175]
  s_waitcnt vmcnt(14)
  v_exp_f32 v248, v248
L_join:
  v_mfma_f32_16x16x32_bf16 a[192:195], v[32:35], v[208:211], 0
  s_waitcnt vmcnt(13)
  v_exp_f32 v249, v249
  v_mfma_f32_16x16x32_bf16 a[192:195], v[48:51], v[212:215], a[192:195]
  s_waitcnt vmcnt(12)
  buffer_load_dwordx4 a[40:43], v241, s[32:35], s10 offen sc1
  v_add_f32 v248, 1.0, v248
  v_mfma_f32_16x16x32_bf16 a[192:195], v[64:67], v[216:219], a[192:195]
  s_waitcnt vmcnt(12)
  v_exp_f32 v250, v250
  v_mfma_f32_16x16x32_bf16 a[192:195], v[80:83], a[0:3], a[192:195]
  s_waitcnt vmcnt(11)
  v_exp_f32 v251, v251
  v_mfma_f32_16x16x32_bf16 a[192:195], v[96:99], a[4:7], a[192:195]
  s_waitcnt vmcnt(10)
  s_add_u32 s52, s16, 114688
  v_add_u32 v241, s52, v17
  v_add_f32 v249, 1.0, v249
  v_mfma_f32_16x16x32_bf16 a[192:195], v[112:115], a[8:11], a[192:195]
  s_waitcnt vmcnt(9) lgkmcnt(6)
  buffer_load_dwordx4 a[44:47], v241, s[32:35], s4 offen sc1
  v_add_f32 v250, 1.0, v250
  v_mfma_f32_16x16x32_bf16 a[192:195], v[128:131], a[12:15], a[192:195]
  v_add_f32 v251, 1.0, v251
  v_mul_f32 v165, v161, v165
  v_mfma_f32_16x16x32_bf16 a[196:199], v[36:39], v[208:211], 0
  v_rcp_f32 v248, v248
  v_mfma_f32_16x16x32_bf16 a[196:199], v[52:55], v[212:215], a[196:199]
  v_rcp_f32 v249, v249
  v_mfma_f32_16x16x32_bf16 a[196:199], v[68:71], v[216:219], a[196:199]
  v_rcp_f32 v250, v250
  v_mfma_f32_16x16x32_bf16 a[196:199], v[84:87], a[0:3], a[196:199]
  buffer_load_dwordx4 a[48:51], v241, s[32:35], s5 offen sc1
  v_mul_f32 v166, v162, v166
  v_mfma_f32_16x16x32_bf16 a[196:199], v[100:103], a[4:7], a[196:199]
  v_rcp_f32 v251, v251
  v_mfma_f32_16x16x32_bf16 a[196:199], v[116:119], a[8:11], a[196:199]
  s_waitcnt lgkmcnt(4)
  v_mul_f32 v167, v163, v167
  v_mul_f32 v164, v164, v248
  v_mfma_f32_16x16x32_bf16 a[196:199], v[132:135], a[12:15], a[196:199]
  v_mul_f32 v165, v165, v249
  v_mul_f32 v166, v166, v250
  v_mfma_f32_16x16x32_bf16 a[200:203], v[40:43], v[208:211], 0
  buffer_load_dwordx4 a[52:55], v241, s[32:35], s6 offen sc1
  v_mul_f32 v167, v167, v251
  v_mfma_f32_16x16x32_bf16 a[200:203], v[56:59], v[212:215], a[200:203]
  v_cvt_pk_bf16_f32 v244, v164, v165
  v_cvt_pk_bf16_f32 v245, v166, v167
  v_mfma_f32_16x16x32_bf16 a[200:203], v[72:75], v[216:219], a[200:203]
  v_fma_f32 v252, -v168, v168, s59
  v_fma_f32 v253, -v169, v169, s59
  v_mfma_f32_16x16x32_bf16 a[200:203], v[88:91], a[0:3], a[200:203]
  v_fma_f32 v254, -v170, v170, s59
  v_fma_f32 v255, -v171, v171, s59
  v_mfma_f32_16x16x32_bf16 a[200:203], v[104:107], a[4:7], a[200:203]
  v_mul_f32 v252, v252, v168
  v_mul_f32 v253, v253, v169
  v_mfma_f32_16x16x32_bf16 a[200:203], v[120:123], a[8:11], a[200:203]
  s_waitcnt lgkmcnt(2)
  buffer_load_dwordx4 a[56:59], v241, s[32:35], s7 offen sc1
  v_mul_f32 v254, v254, v170
  v_mfma_f32_16x16x32_bf16 a[200:203], v[136:139], a[12:15], a[200:203]
  v_mul_f32 v255, v255, v171
  v_mul_f32 v172, v168, v172
  v_mfma_f32_16x16x32_bf16 a[204:207], v[44:47], v[208:211], 0
  v_exp_f32 v252, v252
  v_mfma_f32_16x16x32_bf16 a[204:207], v[60:63], v[212:215], a[204:207]
  v_exp_f32 v253, v253
  v_mfma_f32_16x16x32_bf16 a[204:207], v[76:79], v[216:219], a[204:207]
  buffer_load_dwordx4 a[60:63], v241, s[32:35], s8 offen sc1
  v_add_f32 v252, 1.0, v252
  v_mfma_f32_16x16x32_bf16 a[204:207], v[92:95], a[0:3], a[204:207]
  v_exp_f32 v254, v254
  v_mfma_f32_16x16x32_bf16 a[204:207], v[108:111], a[4:7], a[204:207]
  v_exp_f32 v255, v255
  v_mfma_f32_16x16x32_bf16 a[204:207], v[124:127], a[8:11], a[204:207]
  s_waitcnt lgkmcnt(0)
  buffer_load_dwordx2 v[14:15], v16, s[32:35], s14 offen offset:128 sc1
  v_add_f32 v253, 1.0, v253
  v_mfma_f32_16x16x32_bf16 a[204:207], v[140:143], a[12:15], a[204:207]
  s_waitcnt vmcnt(14)
  v_add_f32 v254, 1.0, v254
  v_add_f32 v255, 1.0, v255
  v_mfma_f32_16x16x32_bf16 a[208:211], v[32:35], a[16:19], 0
  s_waitcnt vmcnt(13)
  buffer_load_dwordx4 a[64:67], v241, s[32:35], s9 offen sc1
  v_mul_f32 v173, v169, v173
  v_mfma_f32_16x16x32_bf16 a[208:211], v[48:51], a[20:23], a[208:211]
  s_waitcnt vmcnt(12)
  v_rcp_f32 v252, v252
  v_mfma_f32_16x16x32_bf16 a[208:211], v[64:67], a[24:27], a[208:211]
  s_waitcnt vmcnt(11)
  v_rcp_f32 v253, v253
  v_mfma_f32_16x16x32_bf16 a[208:211], v[80:83], a[28:31], a[208:211]
  s_waitcnt vmcnt(9)
  v_rcp_f32 v254, v254
  v_mfma_f32_16x16x32_bf16 a[208:211], v[96:99], a[32:35], a[208:211]
  s_waitcnt vmcnt(8)
  buffer_load_dwordx4 a[68:71], v241, s[32:35], s10 offen sc1
  v_mul_f32 v174, v170, v174
  v_mfma_f32_16x16x32_bf16 a[208:211], v[112:115], a[36:39], a[208:211]
  s_waitcnt vmcnt(8)
  s_add_u32 s58, s69, 122880
  v_rcp_f32 v255, v255
  v_mfma_f32_16x16x32_bf16 a[208:211], v[128:131], a[40:43], a[208:211]
  v_mul_f32 v175, v171, v175
  v_mul_f32 v172, v172, v252
  v_mfma_f32_16x16x32_bf16 a[212:215], v[36:39], a[16:19], 0
  v_mul_f32 v173, v173, v253
  v_mul_f32 v174, v174, v254
  v_mfma_f32_16x16x32_bf16 a[212:215], v[52:55], a[20:23], a[212:215]
  s_add_u32 s52, s16, 122880
  v_add_u32 v241, s52, v17
  v_mul_f32 v175, v175, v255
  v_mfma_f32_16x16x32_bf16 a[212:215], v[68:71], a[24:27], a[212:215]
  buffer_load_dwordx4 a[72:75], v241, s[32:35], s4 offen sc1
  v_cvt_pk_bf16_f32 v246, v172, v173
  v_mfma_f32_16x16x32_bf16 a[212:215], v[84:87], a[28:31], a[212:215]
  s_cmp_eq_u32 s44, 0
  s_cbranch_scc1 L_slow5
  buffer_store_dwordx2 v[8:9], v30, s[32:35], s13 offen offset:256
L_back5:
  v_mfma_f32_16x16x32_bf16 a[212:215], v[100:103], a[32:35], a[212:215]
  ds_read_b64_tr_b16 a[160:161], v22 offset:0
  v_cvt_pk_bf16_f32 v247, v174, v175
  v_mfma_f32_16x16x32_bf16 a[212:215], v[116:119], a[36:39], a[212:215]
  buffer_store_dwordx4 v[244:247], v17, s[32:35], s58 offen sc1
  v_mfma_f32_16x16x32_bf16 a[212:215], v[132:135], a[40:43], a[212:215]
  buffer_load_dwordx4 a[76:79], v241, s[32:35], s5 offen sc1
  ds_read_b64_tr_b16 a[162:163], v22 offset:2048
  v_mfma_f32_16x16x32_bf16 a[216:219], v[40:43], a[16:19], 0
  ds_read_b64_tr_b16 a[164:165], v23 offset:0
  ds_read_b64_tr_b16 a[166:167], v23 offset:2048
  v_mfma_f32_16x16x32_bf16 a[216:219], v[56:59], a[20:23], a[216:219]
  ds_read_b64_tr_b16 a[168:169], v24 offset:0
  ds_read_b64_tr_b16 a[170:171], v24 offset:2048
  v_mfma_f32_16x16x32_bf16 a[216:219], v[72:75], a[24:27], a[216:219]
  ds_read_b64_tr_b16 a[172:173], v25 offset:0
  ds_read_b64_tr_b16 a[174:175], v25 offset:2048
  v_mfma_f32_16x16x32_bf16 a[216:219], v[88:91], a[28:31], a[216:219]
  ds_read_b64_tr_b16 a[80:81], v22 offset:49152
  ds_read_b64_tr_b16 a[82:83], v22 offset:51200
  v_mfma_f32_16x16x32_bf16 a[216:219], v[104:107], a[32:35], a[216:219]
  buffer_load_dwordx4 a[0:3], v241, s[32:35], s6 offen sc1
  ds_read_b64_tr_b16 a[84:85], v23 offset:49152
  v_mfma_f32_16x16x32_bf16 a[216:219], v[120:123], a[36:39], a[216:219]
  ds_read_b64_tr_b16 a[86:87], v23 offset:51200
  ds_read_b64_tr_b16 a[88:89], v24 offset:49152
  v_mfma_f32_16x16x32_bf16 a[216:219], v[136:139], a[40:43], a[216:219]
  s_waitcnt vmcnt(7)
  ds_read_b64_tr_b16 a[90:91], v24 offset:51200
  v_cmp_ne_u64 vcc, s[48:49], v[14:15]
  v_mfma_f32_16x16x32_bf16 a[220:223], v[44:47], a[16:19], 0
  s_cbranch_vccnz L_f41_re
L_f41:
  ds_read_b64_tr_b16 a[92:93], v25 offset:49152
  ds_read_b64_tr_b16 a[94:95], v25 offset:51200
  v_mfma_f32_16x16x32_bf16 a[220:223], v[60:63], a[20:23], a[220:223]
  buffer_load_dwordx4 a[4:7], v241, s[32:35], s7 offen sc1
  v_add_u32 v22, 0x10000, v22
  v_mfma_f32_16x16x32_bf16 a[220:223], v[76:79], a[24:27], a[220:223]
  v_add_u32 v23, 0x10000, v23
  v_add_u32 v24, 0x10000, v24
  v_mfma_f32_16x16x32_bf16 a[220:223], v[92:95], a[28:31], a[220:223]
  v_add_u32 v25, 0x10000, v25
  v_mfma_f32_16x16x32_bf16 a[220:223], v[108:111], a[32:35], a[220:223]
  ds_read_b64_tr_b16 a[96:97], v22 offset:0
  ds_read_b64_tr_b16 a[98:99], v22 offset:2048
  v_mfma_f32_16x16x32_bf16 a[220:223], v[124:127], a[36:39], a[220:223]
  ds_read_b64_tr_b16 a[100:101], v23 offset:0
  ds_read_b64_tr_b16 a[102:103], v23 offset:2048
  v_mfma_f32_16x16x32_bf16 a[220:223], v[140:143], a[40:43], a[220:223]
  buffer_load_dwordx4 a[8:11], v241, s[32:35], s8 offen sc1
  ds_read_b64_tr_b16 a[104:105], v24 offset:0
  v_mfma_f32_16x16x32_bf16 a[224:227], v[32:35], a[44:47], 0
  ds_read_b64_tr_b16 a[106:107], v24 offset:2048
  ds_read_b64_tr_b16 a[108:109], v25 offset:0
  v_mfma_f32_16x16x32_bf16 a[224:227], v[48:51], a[48:51], a[224:227]
  ds_read_b64_tr_b16 a[110:111], v25 offset:2048
  ds_read_b64_tr_b16 a[112:113], v22 offset:16384
  v_mfma_f32_16x16x32_bf16 a[224:227], v[64:67], a[52:55], a[224:227]
  ds_read_b64_tr_b16 a[114:115], v22 offset:18432
  ds_read_b64_tr_b16 a[116:117], v23 offset:16384
  v_mfma_f32_16x16x32_bf16 a[224:227], v[80:83], a[56:59], a[224:227]
  buffer_load_dwordx4 a[12:15], v241, s[32:35], s9 offen sc1
  ds_read_b64_tr_b16 a[118:119], v23 offset:18432
  v_mfma_f32_16x16x32_bf16 a[224:227], v[96:99], a[60:63], a[224:227]
  s_waitcnt vmcnt(9)
  ds_read_b64_tr_b16 a[120:121], v24 offset:16384
  ds_read_b64_tr_b16 a[122:123], v24 offset:18432
  v_mfma_f32_16x16x32_bf16 a[224:227], v[112:115], a[64:67], a[224:227]
  s_waitcnt vmcnt(8)
  ds_read_b64_tr_b16 a[124:125], v25 offset:16384
  ds_read_b64_tr_b16 a[126:127], v25 offset:18432
  v_mfma_f32_16x16x32_bf16 a[224:227], v[128:131], a[68:71], a[224:227]
  ds_read_b64_tr_b16 a[128:129], v22 offset:32768
  ds_read_b64_tr_b16 a[130:131], v22 offset:34816
  v_mfma_f32_16x16x32_bf16 a[228:231], v[36:39], a[44:47], 0
  ds_read_b64_tr_b16 a[132:133], v23 offset:32768
  ds_read_b64_tr_b16 a[134:135], v23 offset:34816
  v_mfma_f32_16x16x32_bf16 a[228:231], v[52:55], a[48:51], a[228:231]
  buffer_load_dwordx4 a[16:19], v241, s[32:35], s10 offen sc1
  ds_read_b64_tr_b16 a[136:137], v24 offset:32768
  v_mfma_f32_16x16x32_bf16 a[228:231], v[68:71], a[52:55], a[228:231]
  ds_read_b64_tr_b16 a[138:139], v24 offset:34816
  ds_read_b64_tr_b16 a[140:141], v25 offset:32768
  v_mfma_f32_16x16x32_bf16 a[228:231], v[84:87], a[56:59], a[228:231]
  ds_read_b64_tr_b16 a[142:143], v25 offset:34816
  ds_read_b64_tr_b16 a[144:145], v22 offset:49152
  v_mfma_f32_16x16x32_bf16 a[228:231], v[100:103], a[60:63], a[228:231]
  s_add_u32 s52, s17, 0
  ds_read_b64_tr_b16 a[146:147], v22 offset:51200
  v_add_u32 v241, s52, v17
  v_mfma_f32_16x16x32_bf16 a[228:231], v[116:119], a[64:67], a[228:231]
  buffer_load_dwordx4 a[20:23], v241, s[32:35], s4 offen sc1
  ds_read_b64_tr_b16 a[148:149], v23 offset:49152
  v_mfma_f32_16x16x32_bf16 a[228:231], v[132:135], a[68:71], a[228:231]
  ds_read_b64_tr_b16 a[150:151], v23 offset:51200
  ds_read_b64_tr_b16 a[152:153], v24 offset:49152
  v_mfma_f32_16x16x32_bf16 a[232:235], v[40:43], a[44:47], 0
  ds_read_b64_tr_b16 a[154:155], v24 offset:51200
  ds_read_b64_tr_b16 a[156:157], v25 offset:49152
  v_mfma_f32_16x16x32_bf16 a[232:235], v[56:59], a[48:51], a[232:235]
  ds_read_b64_tr_b16 a[158:159], v25 offset:51200
  v_add_u32 v22, 0x10000, v22
  v_mfma_f32_16x16x32_bf16 a[232:235], v[72:75], a[52:55], a[232:235]
  v_add_u32 v23, 0x10000, v23
  v_add_u32 v24, 0x10000, v24
  v_mfma_f32_16x16x32_bf16 a[232:235], v[88:91], a[56:59], a[232:235]
  buffer_load_dwordx4 a[24:27], v241, s[32:35], s5 offen sc1
  v_add_u32 v25, 0x10000, v25
  v_mfma_f32_16x16x32_bf16 a[232:235], v[104:107], a[60:63], a[232:235]
  ds_read_b64_tr_b16 a[176:177], v22 offset:0
  ds_read_b64_tr_b16 a[178:179], v22 offset:2048
  v_mfma_f32_16x16x32_bf16 a[232:235], v[120:123], a[64:67], a[232:235]
  ds_read_b64_tr_b16 a[180:181], v23 offset:0
  ds_read_b64_tr_b16 a[182:183], v23 offset:2048
  v_mfma_f32_16x16x32_bf16 a[232:235], v[136:139], a[68:71], a[232:235]
  ds_read_b64_tr_b16 a[184:185], v24 offset:0
  ds_read_b64_tr_b16 a[186:187], v24 offset:2048
  v_mfma_f32_16x16x32_bf16 a[236:239], v[44:47], a[44:47], 0
  buffer_load_dwordx4 a[28:31], v241, s[32:35], s6 offen sc1
  ds_read_b64_tr_b16 a[188:189], v25 offset:0
  v_mfma_f32_16x16x32_bf16 a[236:239], v[60:63], a[48:51], a[236:239]
  ds_read_b64_tr_b16 a[190:191], v25 offset:2048
  v_mfma_f32_16x16x32_bf16 a[236:239], v[76:79], a[52:55], a[236:239]
  v_mfma_f32_16x16x32_bf16 a[236:239], v[92:95], a[56:59], a[236:239]
  buffer_load_dwordx2 v[12:13], v16, s[32:35], s14 offen offset:256 sc1
  v_mfma_f32_16x16x32_bf16 a[236:239], v[108:111], a[60:63], a[236:239]
  v_mfma_f32_16x16x32_bf16 a[236:239], v[124:127], a[64:67], a[236:239]
  buffer_load_dwordx4 a[32:35], v241, s[32:35], s7 offen sc1
  v_mfma_f32_16x16x32_bf16 a[236:239], v[140:143], a[68:71], a[236:239]
  s_waitcnt vmcnt(13)
  v_mfma_f32_16x16x32_bf16 a[240:243], v[32:35], a[72:75], 0
  s_waitcnt vmcnt(10)
  v_mfma_f32_16x16x32_bf16 a[240:243], v[48:51], a[76:79], a[240:243]
  s_waitcnt vmcnt(9)
  v_mfma_f32_16x16x32_bf16 a[240:243], v[64:67], a[0:3], a[240:243]
  s_waitcnt vmcnt(8)
  buffer_load_dwordx4 a[36:39], v241, s[32:35], s8 offen sc1
  v_mfma_f32_16x16x32_bf16 a[240:243], v[80:83], a[4:7], a[240:243]
  s_waitcnt vmcnt(8)
  v_mfma_f32_16x16x32_bf16 a[240:243], v[96:99], a[8:11], a[240:243]
  s_waitcnt vmcnt(7)
  s_cmp_eq_u32 s44, 0
  s_cbranch_scc1 L_slow6
  buffer_store_dwordx2 v[8:9], v30, s[32:35], s13 offen offset:384
L_back6:
  v_mfma_f32_16x16x32_bf16 a[240:243], v[112:115], a[12:15], a[240:243]
  s_waitcnt vmcnt(7)
  v_mfma_f32_16x16x32_bf16 a[240:243], v[128:131], a[16:19], a[240:243]
  v_mfma_f32_16x16x32_bf16 a[244:247], v[36:39], a[72:75], 0
  buffer_load_dwordx4 a[40:43], v241, s[32:35], s9 offen sc1
  v_mfma_f32_16x16x32_bf16 a[244:247], v[52:55], a[76:79], a[244:247]
  v_mfma_f32_16x16x32_bf16 a[244:247], v[68:71], a[0:3], a[244:247]
  v_mfma_f32_16x16x32_bf16 a[244:247], v[84:87], a[4:7], a[244:247]
  v_mfma_f32_16x16x32_bf16 a[244:247], v[100:103], a[8:11], a[244:247]
  buffer_load_dwordx4 a[44:47], v241, s[32:35], s10 offen sc1
  v_mfma_f32_16x16x32_bf16 a[244:247], v[116:119], a[12:15], a[244:247]
  v_and_b32 v4, 7, v2
  v_xor_b32 v4, v4, v3
  v_mfma_f32_16x16x32_bf16 a[244:247], v[132:135], a[16:19], a[244:247]
  v_lshlrev_b32 v4, 4, v4
  v_lshl_add_u32 v4, v2, 8, v4
  v_mfma_f32_16x16x32_bf16 a[248:251], v[40:43], a[72:75], 0
  v_lshl_add_u32 v4, v6, 14, v4
  v_add_u32 v18, 0x10000, v4
  v_mfma_f32_16x16x32_bf16 a[248:251], v[56:59], a[76:79], a[248:251]
  s_add_u32 s52, s17, 8192
  v_add_u32 v241, s52, v17
  v_xor_b32 v19, 64, v18
  v_mfma_f32_16x16x32_bf16 a[248:251], v[72:75], a[0:3], a[248:251]
  buffer_load_dwordx4 a[48:51], v241, s[32:35], s4 offen sc1
  v_xor_b32 v20, 0x80, v18
  v_mfma_f32_16x16x32_bf16 a[248:251], v[88:91], a[4:7], a[248:251]
  v_xor_b32 v21, 0xc0, v18
  v_mfma_f32_16x16x32_bf16 a[248:251], v[104:107], a[8:11], a[248:251]
  s_waitcnt vmcnt(6)
  v_cmp_ne_u64 vcc, s[48:49], v[12:13]
  v_mfma_f32_16x16x32_bf16 a[248:251], v[120:123], a[12:15], a[248:251]
  s_cbranch_vccnz L_f42_re
L_f42:
  v_mfma_f32_16x16x32_bf16 a[248:251], v[136:139], a[16:19], a[248:251]
  buffer_load_dwordx4 a[52:55], v241, s[32:35], s5 offen sc1
  v_mfma_f32_16x16x32_bf16 a[252:255], v[44:47], a[72:75], 0
  v_mfma_f32_16x16x32_bf16 a[252:255], v[60:63], a[76:79], a[252:255]
  v_mfma_f32_16x16x32_bf16 a[252:255], v[76:79], a[0:3], a[252:255]
  v_mfma_f32_16x16x32_bf16 a[252:255], v[92:95], a[4:7], a[252:255]
  v_mfma_f32_16x16x32_bf16 a[252:255], v[108:111], a[8:11], a[252:255]
  buffer_load_dwordx4 a[56:59], v241, s[32:35], s6 offen sc1
  v_mfma_f32_16x16x32_bf16 a[252:255], v[124:127], a[12:15], a[252:255]
  v_mfma_f32_16x16x32_bf16 a[252:255], v[140:143], a[16:19], a[252:255]
  s_waitcnt lgkmcnt(0)
  s_barrier
  v_mfma_f32_16x16x32_bf16 a[192:195], a[80:83], a[20:23], a[192:195]
  s_lshl_b32 s60, s40, 1
  v_mfma_f32_16x16x32_bf16 a[192:195], a[96:99], a[24:27], a[192:195]
  s_lshr_b32 s60, 0x78, s60
  buffer_load_dwordx4 a[60:63], v241, s[32:35], s7 offen sc1
  v_mfma_f32_16x16x32_bf16 a[192:195], a[112:115], a[28:31], a[192:195]
  s_waitcnt vmcnt(8)
  s_mov_b32 s58, 0x4091afa3
  v_mfma_f32_16x16x32_bf16 a[192:195], a[128:131], a[32:35], a[192:195]
  s_waitcnt vmcnt(7)
  s_add_u32 s61, s3, 4096
  v_lshrrev_b32 v4, 1, v2
  v_mfma_f32_16x16x32_bf16 a[192:195], a[144:147], a[36:39], a[192:195]
  s_waitcnt vmcnt(5)
  v_xor_b32 v5, s60, v4
  v_bfi_b32 v4, 3, v5, v4
  v_mfma_f32_16x16x32_bf16 a[192:195], a[160:163], a[40:43], a[192:195]
  s_waitcnt vmcnt(4)
  v_and_b32 v5, 1, v2
  v_lshlrev_b32 v5, 3, v5
  v_mfma_f32_16x16x32_bf16 a[192:195], a[176:179], a[44:47], a[192:195]
  buffer_load_dwordx4 a[64:67], v241, s[32:35], s8 offen sc1
  v_lshl_add_u32 v4, v4, 5, v5
  v_mfma_f32_16x16x32_bf16 a[196:199], a[84:87], a[20:23], a[196:199]
  v_lshrrev_b32 v5, 1, v3
  v_lshl_add_u32 v4, v5, 8, v4
  v_mfma_f32_16x16x32_bf16 a[196:199], a[100:103], a[24:27], a[196:199]
  v_and_or_b32 v4, v1, 16, v4
  v_add_u32 v27, s47, v4
  v_mfma_f32_16x16x32_bf16 a[196:199], a[116:119], a[28:31], a[196:199]
  v_lshl_add_u32 v29, v3, 4, s47
  v_mfma_f32_16x16x32_bf16 a[196:199], a[132:135], a[32:35], a[196:199]
  buffer_load_dwordx4 a[68:71], v241, s[32:35], s9 offen sc1
  ds_read_b64 v[160:161], v27 offset:32768
  v_mfma_f32_16x16x32_bf16 a[196:199], a[148:151], a[36:39], a[196:199]
  ds_read_b64 v[168:169], v29 offset:34824
  ds_read_b64 v[162:163], v27 offset:33280
  v_mfma_f32_16x16x32_bf16 a[196:199], a[164:167], a[40:43], a[196:199]
  ds_read_b64 v[170:171], v29 offset:34888
  ds_read_b64 v[164:165], v27 offset:33792
  v_mfma_f32_16x16x32_bf16 a[196:199], a[180:183], a[44:47], a[196:199]
  ds_read_b64 v[172:173], v29 offset:34952
  ds_read_b64 v[166:167], v27 offset:34304
  v_mfma_f32_16x16x32_bf16 a[200:203], a[88:91], a[20:23], a[200:203]
  ds_write_b128 v18, a[192:195] offset:0
  ds_read_b64 v[174:175], v29 offset:35016
  v_mfma_f32_16x16x32_bf16 a[200:203], a[104:107], a[24:27], a[200:203]
  buffer_load_dwordx4 a[72:75], v241, s[32:35], s10 offen sc1
  v_lshl_add_u32 v4, v6, 2, v3
  v_mfma_f32_16x16x32_bf16 a[200:203], a[120:123], a[28:31], a[200:203]
  v_and_b32 v5, 7, v4
  v_xor_b32 v7, v5, v2
  v_mfma_f32_16x16x32_bf16 a[200:203], a[136:139], a[32:35], a[200:203]
  v_lshlrev_b32 v7, 4, v7
  v_lshl_add_u32 v7, v4, 8, v7
  v_mfma_f32_16x16x32_bf16 a[200:203], a[152:155], a[36:39], a[200:203]
  s_add_u32 s52, s17, 114688
  buffer_load_dwordx2 v[14:15], v16, s[32:35], s14 offen offset:384 sc1
  v_add_u32 v241, s52, v17
  v_mfma_f32_16x16x32_bf16 a[200:203], a[168:171], a[40:43], a[200:203]
  v_add_u32 v28, 0x10000, v7
  v_lshrrev_b32 v4, 3, v4
  v_mfma_f32_16x16x32_bf16 a[200:203], a[184:187], a[44:47], a[200:203]
  buffer_load_dwordx4 a[76:79], v241, s[32:35], s4 offen sc1
  v_lshlrev_b32 v4, 10, v4
  v_mfma_f32_16x16x32_bf16 a[204:207], a[92:95], a[20:23], a[204:207]
  ds_write_b128 v19, a[196:199] offset:0
  v_lshl_add_u32 v4, v2, 3, v4
  v_mfma_f32_16x16x32_bf16 a[204:207], a[108:111], a[24:27], a[204:207]
  buffer_load_dwordx4 a[0:3], v241, s[32:35], s5 offen sc1
  v_lshl_add_u32 v26, v5, 18, v4
  v_mfma_f32_16x16x32_bf16 a[204:207], a[124:127], a[28:31], a[204:207]
  s_waitcnt lgkmcnt(9)
  v_lshlrev_b32 v96, 16, v160
  v_and_b32 v97, s57, v160
  v_mfma_f32_16x16x32_bf16 a[204:207], a[140:143], a[32:35], a[204:207]
  buffer_load_dwordx4 a[4:7], v241, s[32:35], s6 offen sc1
  v_lshlrev_b32 v98, 16, v161
  v_mfma_f32_16x16x32_bf16 a[204:207], a[156:159], a[36:39], a[204:207]
  v_and_b32 v99, s57, v161
  s_waitcnt lgkmcnt(7)
  v_lshlrev_b32 v100, 16, v162
  v_mfma_f32_16x16x32_bf16 a[204:207], a[172:175], a[40:43], a[204:207]
  buffer_load_dwordx4 a[8:11], v241, s[32:35], s7 offen sc1
  v_and_b32 v101, s57, v162
  v_mfma_f32_16x16x32_bf16 a[204:207], a[188:191], a[44:47], a[204:207]
  s_waitcnt vmcnt(11)
  v_lshlrev_b32 v102, 16, v163
  v_and_b32 v103, s57, v163
  v_mfma_f32_16x16x32_bf16 a[208:211], a[80:83], a[48:51], a[208:211]
  s_waitcnt vmcnt(10)
  buffer_load_dwordx4 a[12:15], v241, s[32:35], s8 offen sc1
  ds_write_b128 v20, a[200:203] offset:0
  v_mfma_f32_16x16x32_bf16 a[208:211], a[96:99], a[52:55], a[208:211]
  s_waitcnt vmcnt(10)
  s_waitcnt lgkmcnt(6)
  v_lshlrev_b32 v104, 16, v164
  v_and_b32 v105, s57, v164
  v_mfma_f32_16x16x32_bf16 a[208:211], a[112:115], a[56:59], a[208:211]
  s_waitcnt vmcnt(9)
  buffer_load_dwordx4 a[16:19], v241, s[32:35], s9 offen sc1
  v_lshlrev_b32 v106, 16, v165
  v_mfma_f32_16x16x32_bf16 a[208:211], a[128:131], a[60:63], a[208:211]
  s_waitcnt vmcnt(9)
  v_and_b32 v107, s57, v165
  s_waitcnt lgkmcnt(4)
  v_lshlrev_b32 v108, 16, v166
  v_mfma_f32_16x16x32_bf16 a[208:211], a[144:147], a[64:67], a[208:211]
  s_waitcnt vmcnt(8)
  buffer_load_dwordx4 v[220:223], v241, s[32:35], s10 offen sc1
  v_and_b32 v109, s57, v166
  v_mfma_f32_16x16x32_bf16 a[208:211], a[160:163], a[68:71], a[208:211]
  s_waitcnt vmcnt(8)
  v_lshlrev_b32 v110, 16, v167
  v_and_b32 v111, s57, v167
  v_mfma_f32_16x16x32_bf16 a[208:211], a[176:179], a[72:75], a[208:211]
  v_fma_f32 v96, v96, v169, v168
  v_fma_f32 v97, v97, v169, v168
  v_mfma_f32_16x16x32_bf16 a[212:215], a[84:87], a[48:51], a[212:215]
  ds_write_b128 v21, a[204:207] offset:0
  v_fma_f32 v98, v98, v169, v168
  v_mfma_f32_16x16x32_bf16 a[212:215], a[100:103], a[52:55], a[212:215]
  v_fma_f32 v99, v99, v169, v168
  v_fma_f32 v100, v100, v171, v170
  v_mfma_f32_16x16x32_bf16 a[212:215], a[116:119], a[56:59], a[212:215]
  v_fma_f32 v101, v101, v171, v170
  v_fma_f32 v102, v102, v171, v170
  v_mfma_f32_16x16x32_bf16 a[212:215], a[132:135], a[60:63], a[212:215]
  v_fma_f32 v103, v103, v171, v170
  v_fma_f32 v104, v104, v173, v172
  v_mfma_f32_16x16x32_bf16 a[212:215], a[148:151], a[64:67], a[212:215]
  s_waitcnt lgkmcnt(0)
  s_barrier
  v_fma_f32 v105, v105, v173, v172
  v_fma_f32 v106, v106, v173, v172
  v_mfma_f32_16x16x32_bf16 a[212:215], a[164:167], a[68:71], a[212:215]
L_page6:
  s_cbranch_execz L_hop456
  s_waitcnt vmcnt(7)
  v_cmp_ne_u64 vcc, s[48:49], v[14:15]
  v_fma_f32 v107, v107, v173, v172
  v_mfma_f32_16x16x32_bf16 a[212:215], a[180:183], a[72:75], a[212:215]
  s_cbranch_vccnz L_f43_re
L_f43:
  v_fma_f32 v108, v108, v175, v174
  v_fma_f32 v109, v109, v175, v174
  v_mfma_f32_16x16x32_bf16 a[216:219], a[88:91], a[48:51], a[216:219]
  s_add_u32 s52, s17, 122880
  ds_write_b128 v18, a[208:211] offset:4096
  v_add_u32 v241, s52, v17
  v_mfma_f32_16x16x32_bf16 a[216:219], a[104:107], a[52:55], a[216:219]
  buffer_load_dwordx4 v[224:227], v241, s[32:35], s4 offen sc1
  v_fma_f32 v110, v110, v175, v174
  v_mfma_f32_16x16x32_bf16 a[216:219], a[120:123], a[56:59], a[216:219]
  ds_read_b128 v[32:35], v28 offset:0
  v_fma_f32 v111, v111, v175, v174
  v_mfma_f32_16x16x32_bf16 a[216:219], a[136:139], a[60:63], a[216:219]
  buffer_load_dwordx4 v[228:231], v241, s[32:35], s5 offen sc1
  ds_read_b128 v[36:39], v28 offset:16384
  v_mfma_f32_16x16x32_bf16 a[216:219], a[152:155], a[64:67], a[216:219]
  ds_read_b128 v[40:43], v28 offset:32768
  ds_read_b128 v[44:47], v28 offset:49152
  v_mfma_f32_16x16x32_bf16 a[216:219], a[168:171], a[68:71], a[216:219]
  buffer_load_dwordx4 v[232:235], v241, s[32:35], s6 offen sc1
  v_mfma_f32_16x16x32_bf16 a[216:219], a[184:187], a[72:75], a[216:219]
  v_mfma_f32_16x16x32_bf16 a[220:223], a[92:95], a[48:51], a[220:223]
  buffer_load_dwordx4 v[236:239], v241, s[32:35], s7 offen sc1
  ds_write_b128 v19, a[212:215] offset:4096
  v_mfma_f32_16x16x32_bf16 a[220:223], a[108:111], a[52:55], a[220:223]
  v_mfma_f32_16x16x32_bf16 a[220:223], a[124:127], a[56:59], a[220:223]
  s_waitcnt lgkmcnt(1)
  buffer_load_dwordx4 v[176:179], v241, s[32:35], s8 offen sc1
  v_add_f32 v32, v32, v36
  v_mfma_f32_16x16x32_bf16 a[220:223], a[140:143], a[60:63], a[220:223]
  v_add_f32 v33, v33, v37
  v_add_f32 v34, v34, v38
  v_mfma_f32_16x16x32_bf16 a[220:223], a[156:159], a[64:67], a[220:223]
  buffer_load_dwordx4 v[180:183], v241, s[32:35], s9 offen sc1
  v_add_f32 v35, v35, v39
  v_mfma_f32_16x16x32_bf16 a[220:223], a[172:175], a[68:71], a[220:223]
  v_add_f32 v40, v40, v44
  v_add_f32 v41, v41, v45
  v_mfma_f32_16x16x32_bf16 a[220:223], a[188:191], a[72:75], a[220:223]
  s_waitcnt vmcnt(12)
  buffer_load_dwordx4 v[184:187], v241, s[32:35], s10 offen sc1
  v_add_f32 v42, v42, v46
  v_mfma_f32_16x16x32_bf16 a[224:227], a[80:83], a[76:79], a[224:227]
  s_waitcnt vmcnt(12)
  ds_write_b128 v20, a[216:219] offset:4096
  v_add_f32 v43, v43, v47
  v_mfma_f32_16x16x32_bf16 a[224:227], a[96:99], a[0:3], a[224:227]
  s_waitcnt vmcnt(11)
  v_add_f32 v32, v32, v40
  v_add_f32 v33, v33, v41
  v_mfma_f32_16x16x32_bf16 a[224:227], a[112:115], a[4:7], a[224:227]
  s_waitcnt vmcnt(10)
  v_add_f32 v34, v34, v42
  v_add_f32 v35, v35, v43
  v_mfma_f32_16x16x32_bf16 a[224:227], a[128:131], a[8:11], a[224:227]
  s_waitcnt vmcnt(9)
  v_fma_f32 v32, v32, s58, v96
  v_fma_f32 v33, v33, s58, v97
  v_mfma_f32_16x16x32_bf16 a[224:227], a[144:147], a[12:15], a[224:227]
  s_waitcnt vmcnt(8)
  v_fma_f32 v34, v34, s58, v98
  v_fma_f32 v35, v35, s58, v99
  v_mfma_f32_16x16x32_bf16 a[224:227], a[160:163], a[16:19], a[224:227]
  s_waitcnt vmcnt(7)
  v_cvt_pk_bf16_f32 v160, v32, v33
  v_cvt_pk_bf16_f32 v161, v34, v35
  v_mfma_f32_16x16x32_bf16 a[224:227], a[176:179], v[220:223], a[224:227]
  buffer_store_dwordx2 v[160:161], v26, s[36:39], s3 offen offset:0 sc1
  v_mfma_f32_16x16x32_bf16 a[228:231], a[84:87], a[76:79], a[228:231]
  ds_write_b128 v21, a[220:223] offset:4096
  v_mfma_f32_16x16x32_bf16 a[228:231], a[100:103], a[0:3], a[228:231]
  v_mfma_f32_16x16x32_bf16 a[228:231], a[116:119], a[4:7], a[228:231]
  v_mfma_f32_16x16x32_bf16 a[228:231], a[132:135], a[8:11], a[228:231]
  v_mfma_f32_16x16x32_bf16 a[228:231], a[148:151], a[12:15], a[228:231]
  s_waitcnt lgkmcnt(0)
  s_barrier
  v_mfma_f32_16x16x32_bf16 a[228:231], a[164:167], a[16:19], a[228:231]
  ds_read_b128 v[48:51], v28 offset:4096
  ds_read_b128 v[52:55], v28 offset:20480
  v_mfma_f32_16x16x32_bf16 a[228:231], a[180:183], v[220:223], a[228:231]
  ds_read_b128 v[56:59], v28 offset:36864
  ds_read_b128 v[60:63], v28 offset:53248
  v_mfma_f32_16x16x32_bf16 a[232:235], a[88:91], a[76:79], a[232:235]
  ds_write_b128 v18, a[224:227] offset:8192
  v_mfma_f32_16x16x32_bf16 a[232:235], a[104:107], a[0:3], a[232:235]
  v_mfma_f32_16x16x32_bf16 a[232:235], a[120:123], a[4:7], a[232:235]
  v_mfma_f32_16x16x32_bf16 a[232:235], a[136:139], a[8:11], a[232:235]
  v_mfma_f32_16x16x32_bf16 a[232:235], a[152:155], a[12:15], a[232:235]
  s_waitcnt lgkmcnt(1)
  v_add_f32 v48, v48, v52
  v_add_f32 v49, v49, v53
  v_mfma_f32_16x16x32_bf16 a[232:235], a[168:171], a[16:19], a[232:235]
  v_add_f32 v50, v50, v54
  v_add_f32 v51, v51, v55
  v_mfma_f32_16x16x32_bf16 a[232:235], a[184:187], v[220:223], a[232:235]
  v_add_f32 v56, v56, v60
  v_add_f32 v57, v57, v61
  v_mfma_f32_16x16x32_bf16 a[236:239], a[92:95], a[76:79], a[236:239]
  ds_write_b128 v19, a[228:231] offset:8192
  v_add_f32 v58, v58, v62
  v_mfma_f32_16x16x32_bf16 a[236:239], a[108:111], a[0:3], a[236:239]
  v_add_f32 v59, v59, v63
  v_add_f32 v48, v48, v56
  v_mfma_f32_16x16x32_bf16 a[236:239], a[124:127], a[4:7], a[236:239]
  v_add_f32 v49, v49, v57
  v_add_f32 v50, v50, v58
  v_mfma_f32_16x16x32_bf16 a[236:239], a[140:143], a[8:11], a[236:239]
  v_add_f32 v51, v51, v59
  v_fma_f32 v48, v48, s58, v100
  v_mfma_f32_16x16x32_bf16 a[236:239], a[156:159], a[12:15], a[236:239]
  v_fma_f32 v49, v49, s58, v101
  v_fma_f32 v50, v50, s58, v102
  v_mfma_f32_16x16x32_bf16 a[236:239], a[172:175], a[16:19], a[236:239]
  v_fma_f32 v51, v51, s58, v103
  v_cvt_pk_bf16_f32 v162, v48, v49
  v_mfma_f32_16x16x32_bf16 a[236:239], a[188:191], v[220:223], a[236:239]
  s_waitcnt vmcnt(7)
  v_cvt_pk_bf16_f32 v163, v50, v51
  v_mfma_f32_16x16x32_bf16 a[240:243], a[80:83], v[224:227], a[240:243]
  s_waitcnt vmcnt(6)
  ds_write_b128 v20, a[232:235] offset:8192
  buffer_store_dwordx2 v[162:163], v26, s[36:39], s3 offen offset:2048 sc1
  v_mfma_f32_16x16x32_bf16 a[240:243], a[96:99], v[228:231], a[240:243]
  s_waitcnt vmcnt(6)
  v_mfma_f32_16x16x32_bf16 a[240:243], a[112:115], v[232:235], a[240:243]
  s_waitcnt vmcnt(5)
  v_mfma_f32_16x16x32_bf16 a[240:243], a[128:131], v[236:239], a[240:243]
  s_waitcnt vmcnt(4)
  v_mfma_f32_16x16x32_bf16 a[240:243], a[144:147], v[176:179], a[240:243]
  s_waitcnt vmcnt(3)
  v_mfma_f32_16x16x32_bf16 a[240:243], a[160:163], v[180:183], a[240:243]
  s_waitcnt vmcnt(2)
  v_mfma_f32_16x16x32_bf16 a[240:243], a[176:179], v[184:187], a[240:243]
  v_mfma_f32_16x16x32_bf16 a[244:247], a[84:87], v[224:227], a[244:247]
  ds_write_b128 v21, a[236:239] offset:8192
  v_mfma_f32_16x16x32_bf16 a[244:247], a[100:103], v[228:231], a[244:247]
  v_mfma_f32_16x16x32_bf16 a[244:247], a[116:119], v[232:235], a[244:247]
  v_mfma_f32_16x16x32_bf16 a[244:247], a[132:135], v[236:239], a[244:247]
  v_mfma_f32_16x16x32_bf16 a[244:247], a[148:151], v[176:179], a[244:247]
  s_waitcnt lgkmcnt(0)
  s_barrier
  v_mfma_f32_16x16x32_bf16 a[244:247], a[164:167], v[180:183], a[244:247]
  ds_read_b128 v[64:67], v28 offset:8192
  ds_read_b128 v[68:71], v28 offset:24576
  v_mfma_f32_16x16x32_bf16 a[244:247], a[180:183], v[184:187], a[244:247]
  ds_read_b128 v[72:75], v28 offset:40960
  ds_read_b128 v[76:79], v28 offset:57344
  v_mfma_f32_16x16x32_bf16 a[248:251], a[88:91], v[224:227], a[248:251]
  ds_write_b128 v18, a[240:243] offset:12288
  v_mfma_f32_16x16x32_bf16 a[248:251], a[104:107], v[228:231], a[248:251]
  v_mfma_f32_16x16x32_bf16 a[248:251], a[120:123], v[232:235], a[248:251]
  v_mfma_f32_16x16x32_bf16 a[248:251], a[136:139], v[236:239], a[248:251]
  v_mfma_f32_16x16x32_bf16 a[248:251], a[152:155], v[176:179], a[248:251]
  s_waitcnt lgkmcnt(1)
  v_add_f32 v64, v64, v68
  v_add_f32 v65, v65, v69
  v_mfma_f32_16x16x32_bf16 a[248:251], a[168:171], v[180:183], a[248:251]
  v_add_f32 v66, v66, v70
  v_add_f32 v67, v67, v71
  v_mfma_f32_16x16x32_bf16 a[248:251], a[184:187], v[184:187], a[248:251]
  v_add_f32 v72, v72, v76
  v_add_f32 v73, v73, v77
  v_mfma_f32_16x16x32_bf16 a[252:255], a[92:95], v[224:227], a[252:255]
  ds_write_b128 v19, a[244:247] offset:12288
  v_add_f32 v74, v74, v78
  v_mfma_f32_16x16x32_bf16 a[252:255], a[108:111], v[228:231], a[252:255]
  v_add_f32 v75, v75, v79
  v_add_f32 v64, v64, v72
  v_mfma_f32_16x16x32_bf16 a[252:255], a[124:127], v[232:235], a[252:255]
  v_add_f32 v65, v65, v73
  v_add_f32 v66, v66, v74
  v_mfma_f32_16x16x32_bf16 a[252:255], a[140:143], v[236:239], a[252:255]
  v_add_f32 v67, v67, v75
  v_fma_f32 v64, v64, s58, v104
  v_mfma_f32_16x16x32_bf16 a[252:255], a[156:159], v[176:179], a[252:255]
  v_fma_f32 v65, v65, s58, v105
  v_fma_f32 v66, v66, s58, v106
  v_mfma_f32_16x16x32_bf16 a[252:255], a[172:175], v[180:183], a[252:255]
  v_fma_f32 v67, v67, s58, v107
  v_cvt_pk_bf16_f32 v164, v64, v65
  v_mfma_f32_16x16x32_bf16 a[252:255], a[188:191], v[184:187], a[252:255]
  v_cvt_pk_bf16_f32 v165, v66, v67
  buffer_store_dwordx2 v[164:165], v26, s[36:39], s61 offen offset:0 sc1
  ds_write_b128 v20, a[248:251] offset:12288
  s_nop 4
  ds_write_b128 v21, a[252:255] offset:12288
  s_mov_b32 s59, s58
  s_waitcnt lgkmcnt(0)
  s_barrier
  ds_read_b128 v[80:83], v28 offset:12288
  ds_read_b128 v[84:87], v28 offset:28672
  ds_read_b128 v[88:91], v28 offset:45056
  ds_read_b128 v[92:95], v28 offset:61440
  s_waitcnt lgkmcnt(2)
  v_pk_add_f32 v[80:81], v[80:81], v[84:85]
  v_pk_add_f32 v[82:83], v[82:83], v[86:87]
  s_waitcnt lgkmcnt(0)
  v_pk_add_f32 v[88:89], v[88:89], v[92:93]
  v_pk_add_f32 v[90:91], v[90:91], v[94:95]
  v_pk_add_f32 v[80:81], v[80:81], v[88:89]
  v_pk_add_f32 v[82:83], v[82:83], v[90:91]
  v_pk_fma_f32 v[80:81], v[80:81], s[58:59], v[108:109]
  v_pk_fma_f32 v[82:83], v[82:83], s[58:59], v[110:111]
  v_cvt_pk_bf16_f32 v166, v80, v81
  v_cvt_pk_bf16_f32 v167, v82, v83
  buffer_store_dwordx2 v[166:167], v26, s[36:39], s61 offen offset:2048 sc1
L_end:
  s_endpgm
L_touch:
  s_sub_u32 s58, s2, 224
  s_lshl2_add_u32 s58, s58, s40
  s_lshl_b32 s58, s58, 10
  s_add_u32 s69, s58, 4456448
  s_lshl_b32 s58, s2, 2
  s_add_u32 s58, s58, s40
  s_cmp_lg_u32 s58, 1023
  s_cbranch_scc1 L_nogen
  s_mov_b32 s58, 4227072
  s_mov_b64 exec, 1
  buffer_store_dwordx2 v[8:9], off, s[32:35], s58 sc1
  s_mov_b64 exec, -1
L_nogen:
  s_and_b32 s60, s42, 3
  s_lshl_b32 s60, s60, 16
  s_add_u32 s60, s60, 0x180
  v_lshrrev_b32 v251, 2, v0
  v_lshlrev_b32 v251, 10, v251
  v_add_u32 v251, s60, v251
  v_lshrrev_b32 v4, 3, v1
  v_and_b32 v5, 6, v4
  v_and_b32 v7, 7, v1
  v_xor_b32 v5, v5, v7
  v_lshlrev_b32 v5, 4, v5
  v_lshl_add_u32 v18, v4, 10, v5
  v_add_u32 v19, 7168, v18
  v_add_u32 v20, 14336, v18
  v_add_u32 v21, 21504, v18
  s_waitcnt vmcnt(0) lgkmcnt(0)
  s_barrier
  s_and_b32 s61, s42, 3
  s_lshl2_add_u32 s60, s41, s61
  s_lshl_b32 s60, s60, 12
  s_add_u32 s60, s60, 4325376
  v_lshlrev_b32 v248, 4, v0
  v_and_b32 v248, 3968, v248
  buffer_load_dword v159, v248, s[32:35], s60 offen sc1
  s_lshl4_add_u32 s61, s4, s18
  s_add_u32 m0, s47, 16384
  s_nop 0
  buffer_load_dwordx4 v18, s[28:31], s61 offen offset:0 lds
  buffer_load_dwordx4 v19, s[28:31], s61 offen offset:1024 lds
  buffer_load_dwordx4 v20, s[28:31], s61 offen offset:2048 lds
  buffer_load_dwordx4 v21, s[28:31], s61 offen offset:3072 lds
  s_lshl4_add_u32 s61, s4, s19
  s_add_u32 m0, s47, 49152
  s_nop 0
  buffer_load_dwordx4 v18, s[28:31], s61 offen offset:0 lds
  buffer_load_dwordx4 v19, s[28:31], s61 offen offset:1024 lds
  buffer_load_dwordx4 v20, s[28:31], s61 offen offset:2048 lds
  buffer_load_dwordx4 v21, s[28:31], s61 offen offset:3072 lds
  s_lshl4_add_u32 s61, s5, s18
  s_add_u32 m0, s47, 32768
  s_nop 0
  buffer_load_dwordx4 v18, s[28:31], s61 offen offset:0 lds
  buffer_load_dwordx4 v19, s[28:31], s61 offen offset:1024 lds
  buffer_load_dwordx4 v20, s[28:31], s61 offen offset:2048 lds
  buffer_load_dwordx4 v21, s[28:31], s61 offen offset:3072 lds
  s_lshl4_add_u32 s61, s5, s19
  s_add_u32 m0, s47, 65536
  s_nop 0
  buffer_load_dwordx4 v18, s[28:31], s61 offen offset:0 lds
  buffer_load_dwordx4 v19, s[28:31], s61 offen offset:1024 lds
  buffer_load_dwordx4 v20, s[28:31], s61 offen offset:2048 lds
  buffer_load_dwordx4 v21, s[28:31], s61 offen offset:3072 lds
  s_waitcnt vmcnt(12)
  ds_read_b64_tr_b16 v[32:33], v22 offset:16384
  ds_read_b64_tr_b16 v[34:35], v22 offset:18432
  ds_read_b64_tr_b16 v[36:37], v23 offset:16384
  ds_read_b64_tr_b16 v[38:39], v23 offset:18432
  ds_read_b64_tr_b16 v[40:41], v24 offset:16384
  ds_read_b64_tr_b16 v[42:43], v24 offset:18432
  ds_read_b64_tr_b16 v[44:45], v25 offset:16384
  ds_read_b64_tr_b16 v[46:47], v25 offset:18432
  s_waitcnt lgkmcnt(0)
  s_lshl4_add_u32 s61, s6, s18
  s_add_u32 m0, s47, 16384
  s_nop 0
  buffer_load_dwordx4 v18, s[28:31], s61 offen offset:0 lds
  buffer_load_dwordx4 v19, s[28:31], s61 offen offset:1024 lds
  buffer_load_dwordx4 v20, s[28:31], s61 offen offset:2048 lds
  buffer_load_dwordx4 v21, s[28:31], s61 offen offset:3072 lds
  s_lshl4_add_u32 s61, s6, s19
  s_add_u32 m0, s47, 81920
  s_nop 0
  buffer_load_dwordx4 v18, s[28:31], s61 offen offset:0 lds
  buffer_load_dwordx4 v19, s[28:31], s61 offen offset:1024 lds
  buffer_load_dwordx4 v20, s[28:31], s61 offen offset:2048 lds
  buffer_load_dwordx4 v21, s[28:31], s61 offen offset:3072 lds
  s_waitcnt vmcnt(12)
  ds_read_b64_tr_b16 v[48:49], v22 offset:32768
  ds_read_b64_tr_b16 v[50:51], v22 offset:34816
  ds_read_b64_tr_b16 v[52:53], v23 offset:32768
  ds_read_b64_tr_b16 v[54:55], v23 offset:34816
  ds_read_b64_tr_b16 v[56:57], v24 offset:32768
  ds_read_b64_tr_b16 v[58:59], v24 offset:34816
  ds_read_b64_tr_b16 v[60:61], v25 offset:32768
  ds_read_b64_tr_b16 v[62:63], v25 offset:34816
  s_waitcnt lgkmcnt(0)
  s_lshl4_add_u32 s61, s7, s18
  s_add_u32 m0, s47, 32768
  s_nop 0
  buffer_load_dwordx4 v18, s[28:31], s61 offen offset:0 lds
  buffer_load_dwordx4 v19, s[28:31], s61 offen offset:1024 lds
  buffer_load_dwordx4 v20, s[28:31], s61 offen offset:2048 lds
  buffer_load_dwordx4 v21, s[28:31], s61 offen offset:3072 lds
  s_lshl4_add_u32 s61, s7, s19
  s_add_u32 m0, s47, 98304
  s_nop 0
  buffer_load_dwordx4 v18, s[28:31], s61 offen offset:0 lds
  buffer_load_dwordx4 v19, s[28:31], s61 offen offset:1024 lds
  buffer_load_dwordx4 v20, s[28:31], s61 offen offset:2048 lds
  buffer_load_dwordx4 v21, s[28:31], s61 offen offset:3072 lds
  s_waitcnt vmcnt(12)
  ds_read_b64_tr_b16 v[64:65], v22 offset:16384
  ds_read_b64_tr_b16 v[66:67], v22 offset:18432
  ds_read_b64_tr_b16 v[68:69], v23 offset:16384
  ds_read_b64_tr_b16 v[70:71], v23 offset:18432
  ds_read_b64_tr_b16 v[72:73], v24 offset:16384
  ds_read_b64_tr_b16 v[74:75], v24 offset:18432
  ds_read_b64_tr_b16 v[76:77], v25 offset:16384
  ds_read_b64_tr_b16 v[78:79], v25 offset:18432
  s_waitcnt lgkmcnt(0)
  s_lshl4_add_u32 s61, s8, s18
  s_add_u32 m0, s47, 16384
  s_nop 0
  buffer_load_dwordx4 v18, s[28:31], s61 offen offset:0 lds
  buffer_load_dwordx4 v19, s[28:31], s61 offen offset:1024 lds
  buffer_load_dwordx4 v20, s[28:31], s61 offen offset:2048 lds
  buffer_load_dwordx4 v21, s[28:31], s61 offen offset:3072 lds
  s_lshl4_add_u32 s61, s8, s19
  s_add_u32 m0, s47, 114688
  s_nop 0
  buffer_load_dwordx4 v18, s[28:31], s61 offen offset:0 lds
  buffer_load_dwordx4 v19, s[28:31], s61 offen offset:1024 lds
  buffer_load_dwordx4 v20, s[28:31], s61 offen offset:2048 lds
  buffer_load_dwordx4 v21, s[28:31], s61 offen offset:3072 lds
  s_waitcnt vmcnt(12)
  ds_read_b64_tr_b16 v[80:81], v22 offset:32768
  ds_read_b64_tr_b16 v[82:83], v22 offset:34816
  ds_read_b64_tr_b16 v[84:85], v23 offset:32768
  ds_read_b64_tr_b16 v[86:87], v23 offset:34816
  ds_read_b64_tr_b16 v[88:89], v24 offset:32768
  ds_read_b64_tr_b16 v[90:91], v24 offset:34816
  ds_read_b64_tr_b16 v[92:93], v25 offset:32768
  ds_read_b64_tr_b16 v[94:95], v25 offset:34816
  s_waitcnt lgkmcnt(0)
  s_lshl4_add_u32 s61, s9, s18
  s_add_u32 m0, s47, 32768
  s_nop 0
  buffer_load_dwordx4 v18, s[28:31], s61 offen offset:0 lds
  buffer_load_dwordx4 v19, s[28:31], s61 offen offset:1024 lds
  buffer_load_dwordx4 v20, s[28:31], s61 offen offset:2048 lds
  buffer_load_dwordx4 v21, s[28:31], s61 offen offset:3072 lds
  s_lshl4_add_u32 s61, s9, s19
  s_add_u32 m0, s47, 0
  s_nop 0
  buffer_load_dwordx4 v18, s[28:31], s61 offen offset:0 lds
  buffer_load_dwordx4 v19, s[28:31], s61 offen offset:1024 lds
  buffer_load_dwordx4 v20, s[28:31], s61 offen offset:2048 lds
  buffer_load_dwordx4 v21, s[28:31], s61 offen offset:3072 lds
  s_waitcnt vmcnt(12)
  ds_read_b64_tr_b16 v[96:97], v22 offset:16384
  ds_read_b64_tr_b16 v[98:99], v22 offset:18432
  ds_read_b64_tr_b16 v[100:101], v23 offset:16384
  ds_read_b64_tr_b16 v[102:103], v23 offset:18432
  ds_read_b64_tr_b16 v[104:105], v24 offset:16384
  ds_read_b64_tr_b16 v[106:107], v24 offset:18432
  ds_read_b64_tr_b16 v[108:109], v25 offset:16384
  ds_read_b64_tr_b16 v[110:111], v25 offset:18432
  s_waitcnt lgkmcnt(0)
  s_lshl4_add_u32 s61, s10, s18
  s_add_u32 m0, s47, 16384
  s_nop 0
  buffer_load_dwordx4 v18, s[28:31], s61 offen offset:0 lds
  buffer_load_dwordx4 v19, s[28:31], s61 offen offset:1024 lds
  buffer_load_dwordx4 v20, s[28:31], s61 offen offset:2048 lds
  buffer_load_dwordx4 v21, s[28:31], s61 offen offset:3072 lds
  s_lshl4_add_u32 s61, s10, s19
  s_add_u32 m0, s47, 131072
  s_nop 0
  buffer_load_dwordx4 v18, s[28:31], s61 offen offset:0 lds
  buffer_load_dwordx4 v19, s[28:31], s61 offen offset:1024 lds
  buffer_load_dwordx4 v20, s[28:31], s61 offen offset:2048 lds
  buffer_load_dwordx4 v21, s[28:31], s61 offen offset:3072 lds
  s_waitcnt vmcnt(12)
  ds_read_b64_tr_b16 v[112:113], v22 offset:32768
  ds_read_b64_tr_b16 v[114:115], v22 offset:34816
  ds_read_b64_tr_b16 v[116:117], v23 offset:32768
  ds_read_b64_tr_b16 v[118:119], v23 offset:34816
  ds_read_b64_tr_b16 v[120:121], v24 offset:32768
  ds_read_b64_tr_b16 v[122:123], v24 offset:34816
  ds_read_b64_tr_b16 v[124:125], v25 offset:32768
  ds_read_b64_tr_b16 v[126:127], v25 offset:34816
  s_waitcnt vmcnt(4)
  ds_read_b64_tr_b16 v[128:129], v22 offset:16384
  ds_read_b64_tr_b16 v[130:131], v22 offset:18432
  ds_read_b64_tr_b16 v[132:133], v23 offset:16384
  ds_read_b64_tr_b16 v[134:135], v23 offset:18432
  ds_read_b64_tr_b16 v[136:137], v24 offset:16384
  ds_read_b64_tr_b16 v[138:139], v24 offset:18432
  ds_read_b64_tr_b16 v[140:141], v25 offset:16384
  ds_read_b64_tr_b16 v[142:143], v25 offset:18432
  s_waitcnt lgkmcnt(0)
  buffer_load_dwordx2 v[12:13], v16, s[32:35], s14 offen offset:0 sc1
  v_lshrrev_b32 v4, 1, v3
  v_and_b32 v5, 1, v3
  v_lshlrev_b32 v4, 14, v4
  v_lshl_add_u32 v4, v5, 11, v4
  v_lshl_add_u32 v4, v2, 4, v4
  s_waitcnt vmcnt(0)
L_tc6:
  v_cmp_ne_u64 vcc, s[48:49], v[12:13]
  s_cbranch_vccz L_tk6
  s_add_u32 s45, s45, 1
  s_cmp_ge_u32 s45, 524288
  s_cbranch_scc1 L_end
  buffer_load_dwordx2 v[12:13], v16, s[32:35], s14 offen offset:0 sc1
  s_waitcnt vmcnt(0)
  s_branch L_tc6
L_tk6:
  v_add_u32 v7, 31744, v4
  v_lshlrev_b32 v5, 2, v2
  s_add_u32 s52, s16, 0
  v_lshl_add_u32 v5, v3, 8, v5
  v_add_u32 v241, s52, v17
  s_add_u32 m0, s47, 32768
  s_nop 0
  buffer_load_dwordx4 v4, s[32:35], s15 offen sc1 lds
  buffer_load_dwordx4 v7, s[32:35], s15 offen offset:1024 sc1 lds
  buffer_load_dword v5, s[32:35], s11 offen offset:2048 sc1 lds
  buffer_load_dwordx4 v[208:211], v241, s[32:35], s4 offen sc1
  buffer_load_dwordx4 v[212:215], v241, s[32:35], s5 offen sc1
  buffer_load_dwordx4 v[216:219], v241, s[32:35], s6 offen sc1
  buffer_load_dwordx4 a[0:3], v241, s[32:35], s7 offen sc1
  buffer_load_dwordx4 a[4:7], v241, s[32:35], s8 offen sc1
  buffer_load_dwordx4 a[8:11], v241, s[32:35], s9 offen sc1
  buffer_load_dwordx4 a[12:15], v241, s[32:35], s10 offen sc1
  s_add_u32 s52, s16, 8192
  v_add_u32 v241, s52, v17
  buffer_load_dwordx4 a[16:19], v241, s[32:35], s4 offen sc1
  buffer_load_dwordx4 a[20:23], v241, s[32:35], s5 offen sc1
  buffer_load_dwordx4 a[24:27], v241, s[32:35], s6 offen sc1
  buffer_load_dwordx4 a[28:31], v241, s[32:35], s7 offen sc1
  buffer_load_dwordx4 a[32:35], v241, s[32:35], s8 offen sc1
  buffer_load_dwordx4 a[36:39], v241, s[32:35], s9 offen sc1
  s_waitcnt vmcnt(0) lgkmcnt(0)
  s_branch L_join

L_x1_re:
  s_add_u32 s45, s45, 1
  s_cmp_ge_u32 s45, 524288
  s_cbranch_scc1 L_end
  buffer_load_dwordx4 v[56:59], v252, s[32:35], s50 offen sc1
  buffer_load_dwordx4 v[60:63], v252, s[32:35], s53 offen sc1
  s_waitcnt vmcnt(0)
  s_branch L_x1
L_pl_re:
  s_add_u32 s45, s45, 1
  s_cmp_ge_u32 s45, 524288
  s_cbranch_scc1 L_end
  buffer_load_dwordx3 v[12:14], v16, s[32:35], s54 offen sc1
  s_waitcnt vmcnt(0)
  s_branch L_pl
L_x2_re:
  s_add_u32 s45, s45, 1
  s_cmp_ge_u32 s45, 524288
  s_cbranch_scc1 L_end
  buffer_load_dwordx4 v[56:59], v254, s[32:35], s51 offen sc1
  buffer_load_dwordx4 v[60:63], v255, s[32:35], s51 offen sc1
  s_waitcnt vmcnt(0)
  s_branch L_x2
L_h0_re:
  s_add_u32 s45, s45, 1
  s_cmp_ge_u32 s45, 524288
  s_cbranch_scc1 L_end
  buffer_load_dwordx4 v[208:211], v242, s[32:35], s66 offen offset:0 sc1
  buffer_load_dwordx4 v[212:215], v242, s[32:35], s66 offen offset:128 sc1
  buffer_load_dwordx4 v[216:219], v242, s[32:35], s66 offen offset:256 sc1
  buffer_load_dwordx4 v[220:223], v242, s[32:35], s66 offen offset:384 sc1
  s_waitcnt vmcnt(0)
  s_branch L_h0
L_h1_re:
  s_add_u32 s45, s45, 1
  s_cmp_ge_u32 s45, 524288
  s_cbranch_scc1 L_end
  buffer_load_dwordx4 v[224:227], v242, s[32:35], s61 offen offset:0 sc1
  buffer_load_dwordx4 v[228:231], v242, s[32:35], s61 offen offset:128 sc1
  buffer_load_dwordx4 v[232:235], v242, s[32:35], s61 offen offset:256 sc1
  buffer_load_dwordx4 v[236:239], v242, s[32:35], s61 offen offset:384 sc1
  s_waitcnt vmcnt(0)
  v_max3_u32 v252, v224, v225, v226
  v_max3_u32 v253, v229, v230, v231
  v_max3_u32 v254, v234, v235, v236
  v_max3_u32 v252, v252, v227, v228
  v_max3_u32 v253, v253, v232, v233
  v_max3_u32 v254, v254, v237, v238
  v_max3_u32 v252, v252, v253, v239
  v_max_u32 v252, v252, v254
  v_cmp_eq_u32 vcc, -1, v252
  s_cbranch_vccnz L_h1_re
  s_branch L_h1
L_f3_re:
  s_add_u32 s45, s45, 1
  s_cmp_ge_u32 s45, 524288
  s_cbranch_scc1 L_end
  buffer_load_dwordx2 v[12:13], v17, s[32:35], s22 offen sc1
  s_waitcnt vmcnt(0)
  v_cmp_ne_u64 vcc, s[48:49], v[12:13]
  s_cbranch_vccnz L_f3_re
  s_branch L_f3
L_f3b_re:
  s_add_u32 s45, s45, 1
  s_cmp_ge_u32 s45, 524288
  s_cbranch_scc1 L_end
  buffer_load_dwordx2 v[14:15], v17, s[32:35], s23 offen sc1
  s_waitcnt vmcnt(0)
  v_cmp_ne_u64 vcc, s[48:49], v[14:15]
  s_cbranch_vccnz L_f3b_re
  s_branch L_f3b
L_f40_re:
  s_add_u32 s45, s45, 1
  s_cmp_ge_u32 s45, 524288
  s_cbranch_scc1 L_end
  buffer_load_dwordx2 v[12:13], v16, s[32:35], s14 offen offset:0 sc1
  s_waitcnt vmcnt(0)
  v_cmp_ne_u64 vcc, s[48:49], v[12:13]
  s_cbranch_vccnz L_f40_re
  s_branch L_f40
L_f41_re:
  s_add_u32 s45, s45, 1
  s_cmp_ge_u32 s45, 524288
  s_cbranch_scc1 L_end
  buffer_load_dwordx2 v[14:15], v16, s[32:35], s14 offen offset:128 sc1
  s_waitcnt vmcnt(0)
  v_cmp_ne_u64 vcc, s[48:49], v[14:15]
  s_cbranch_vccnz L_f41_re
  s_branch L_f41
L_f42_re:
  s_add_u32 s45, s45, 1
  s_cmp_ge_u32 s45, 524288
  s_cbranch_scc1 L_end
  buffer_load_dwordx2 v[12:13], v16, s[32:35], s14 offen offset:256 sc1
  s_waitcnt vmcnt(0)
  v_cmp_ne_u64 vcc, s[48:49], v[12:13]
  s_cbranch_vccnz L_f42_re
  s_branch L_f42
L_f43_re:
  s_add_u32 s45, s45, 1
  s_cmp_ge_u32 s45, 524288
  s_cbranch_scc1 L_end
  buffer_load_dwordx2 v[14:15], v16, s[32:35], s14 offen offset:384 sc1
  s_waitcnt vmcnt(0)
  v_cmp_ne_u64 vcc, s[48:49], v[14:15]
  s_cbranch_vccnz L_f43_re
  s_branch L_f43
L_slow0:
  buffer_store_dwordx4 v[208:211], v252, s[32:35], s50 offen sc1
  buffer_store_dwordx4 v[208:211], v252, s[32:35], s53 offen sc1
  s_nop 1
  s_branch L_back0
L_slow1:
  buffer_store_dwordx4 v[56:59], v252, s[32:35], s53 offen offset:0 sc1
  buffer_store_dwordx4 v[60:63], v252, s[32:35], s53 offen offset:128 sc1
  s_nop 1
  s_branch L_back1
L_slow2:
  buffer_store_dwordx4 v[8:11], v17, s[32:35], s52 offen sc1
  s_nop 1
  s_branch L_back2
L_slow3:
  buffer_store_dwordx2 v[8:9], v30, s[32:35], s12 offen offset:0 sc1
  s_nop 1
  s_branch L_back3
L_slow4:
  buffer_store_dwordx2 v[8:9], v30, s[32:35], s13 offen offset:128 sc1
  s_nop 1
  s_branch L_back4
L_slow5:
  buffer_store_dwordx2 v[8:9], v30, s[32:35], s13 offen offset:256 sc1
  s_nop 1
  s_branch L_back5
L_slow6:
  buffer_store_dwordx2 v[8:9], v30, s[32:35], s13 offen offset:384 sc1
  s_nop 1
  s_branch L_back6
.p2align 8
L_pad:
.fill 4096, 4, 0xbf810000
.section .rodata,"a"
.p2align 6
.amdhsa_kernel sequential_preLN__spectral_gfnet__glu_gated_geglu__prompt_kernel
  .amdhsa_next_free_vgpr 512
  .amdhsa_next_free_sgpr 102
  .amdhsa_accum_offset 256
  .amdhsa_group_segment_fixed_size 0
  .amdhsa_kernarg_size 80
  .amdhsa_user_sgpr_count 2
  .amdhsa_user_sgpr_kernarg_segment_ptr 1
  .amdhsa_system_sgpr_workgroup_id_x 1
.end_amdhsa_kernel
```
